```python
import torch

def _softmax(x, axis=-1):
    return torch.softmax(x, dim=axis)
def _gelu(x):
    return torch.nn.functional.gelu(x, approximate="tanh")
def _silu(x):
    return torch.nn.functional.silu(x)
def _sigmoid(x):
    return torch.sigmoid(x)
def _layernorm(x, axis=-1, eps=1e-5):
    m = x.mean(dim=axis, keepdim=True)
    v = x.var(dim=axis, keepdim=True, unbiased=False)
    return (x - m) / torch.sqrt(v + eps)
def _scatter_add(tgt, idx, src, axis=0):
    return tgt.clone().index_add_(axis, idx, src)
def _segment_sum(src, seg, n):
    out = torch.zeros((n,) + src.shape[1:], dtype=src.dtype)
    return out.index_add_(0, seg, src)
def _pad(x, pw):
    flat = tuple(v for pair in reversed(pw) for v in pair)
    return torch.nn.functional.pad(x, flat)

kernel_name = 'parallel_sum__sliding_block_cached__dense_activation_gelu__decode'

def setup_inputs():

    _w = (lambda a: (lambda t: t.to(torch.bfloat16) if t.is_floating_point() else t)(torch.as_tensor(a)))
    def _A_setup():
        B, Sq, D = 8, 1, 512
        Hq, Hkv, Sk, Dh = 32, 8, 4096, 128
        assert Hq % Hkv == 0, (Hq, Hkv)
        return {
            "x": _w((lambda *s: torch.randn(*s, dtype=torch.bfloat16) * 0.05)(B, Sq, D)),
            "k_cache": _w((lambda *s: torch.randn(*s, dtype=torch.bfloat16) * 3.2)(B, Hkv, Sk, Dh)),
            "v_cache": _w((lambda *s: torch.randn(*s, dtype=torch.bfloat16) * 0.8)(B, Hkv, Sk, Dh)),
            "wq": _w((lambda *s: torch.randn(*s, dtype=torch.bfloat16) * 3.2)(D, Hq * Dh) * (D ** -0.5)),
            "wo": _w((lambda *s: torch.randn(*s, dtype=torch.bfloat16) * 0.8)(Hq * Dh, D) * ((Hq * Dh) ** -0.5)),
        }
    _A_in = _A_setup()

    def _B_setup():
        B, S, D, F = 8, 1, 512, 1792
        return {
            "x": _w((lambda *s: torch.randn(*s, dtype=torch.bfloat16) * 0.05)(B, S, D)),
            "w1": _w((lambda *s: torch.randn(*s, dtype=torch.bfloat16) * 3.2)(D, F) * (D ** -0.5)),
            "b1": _w((lambda *s: torch.randn(*s, dtype=torch.bfloat16) * 3.2)(F) * 0.01),
            "w2": _w((lambda *s: torch.randn(*s, dtype=torch.bfloat16) * 0.4)(F, D) * (F ** -0.5)),
            "b2": _w((lambda *s: torch.randn(*s, dtype=torch.bfloat16) * 0.4)(D) * 0.01),
        }
    _B_in = _B_setup()

    return {
        "A_x": _A_in["x"],
        "A_k_cache": _A_in["k_cache"],
        "A_v_cache": _A_in["v_cache"],
        "A_wq": _A_in["wq"],
        "A_wo": _A_in["wo"],
        "B_x": _B_in["x"],
        "B_w1": _B_in["w1"],
        "B_b1": _B_in["b1"],
        "B_w2": _B_in["w2"],
        "B_b2": _B_in["b2"],
    }

def reference(A_x, A_k_cache, A_v_cache, A_wq, A_wo, B_x, B_w1, B_b1, B_w2, B_b2):
    def _A_ref(x, k_cache, v_cache, wq, wo):
        B, Sq, D = x.shape
        Hq, Dh = 32, 128
        Hkv, Sk = k_cache.shape[1], k_cache.shape[2]
        W = min(4096, max(256, Sk // 4))
        rep = Hq // Hkv
        q = (lambda x, *d: x.permute(*d))((x @ wq).reshape(B, Sq, Hq, Dh), 0, 2, 1, 3)
        k = (lambda x, n, axis: torch.repeat_interleave(x, n, dim=axis))(k_cache[:, :, Sk - W:, :], rep, axis=1)
        v = (lambda x, n, axis: torch.repeat_interleave(x, n, dim=axis))(v_cache[:, :, Sk - W:, :], rep, axis=1)
        scores = torch.einsum("bhqd,bhkd->bhqk", q, k) * (Dh ** -0.5)
        p = _softmax(scores, axis=-1)
        o = torch.einsum("bhqk,bhkd->bhqd", p, v)
        return (lambda x, *d: x.permute(*d))(o, 0, 2, 1, 3).reshape(B, Sq, Hq * Dh) @ wo

    def _B_ref(x, w1, b1, w2, b2):
        h = torch.einsum("bsd,df->bsf", x, w1) + b1
        h = _gelu(h)
        return torch.einsum("bsf,fd->bsd", h, w2) + b2

    x = A_x
    xn = _layernorm(x, axis=-1)
    return x + _A_ref(xn, A_k_cache, A_v_cache, A_wq, A_wo) + _B_ref(xn, B_w1, B_b1, B_w2, B_b2)
```

```asm
; @launch kernel=k0_proj_kernel grid=(256,1,1) block=(320,1,1) lds=34432
; @launch kernel=k1_attn_kernel grid=(256,1,1) block=(320,1,1) lds=34432
; @launch kernel=parallel_sum__sliding_block_cached__dense_activation_gelu__decode_kernel grid=(256,1,1) block=(256,1,1) lds=15616
.amdgcn_target "amdgcn-amd-amdhsa--gfx950"
.text
.globl k0_proj_kernel
.p2align 8
.type k0_proj_kernel,@function
k0_proj_kernel:
    s_cmp_ge_u32 s2, 256
    s_cbranch_scc1 K1A_END
    s_load_dwordx4 s[4:7], s[0:1], 0
    s_load_dwordx4 s[8:11], s[0:1], 16
    s_load_dwordx2 s[12:13], s[0:1], 48
    s_load_dwordx4 s[16:19], s[0:1], 88
    s_mov_b32 s20, 0x05040100
    s_mov_b32 s21, 0x07060302
    s_lshr_b32 s22, s2, 5
    s_and_b32 s23, s2, 31
    s_lshr_b32 s24, s23, 2
    s_and_b32 s25, s23, 3
    s_and_b32 s26, s23, 7
    s_lshr_b32 s27, s23, 3
    v_and_b32 v1, 63, v0
    v_lshrrev_b32 v2, 6, v0
    v_lshrrev_b32 v3, 4, v1
    v_and_b32 v4, 15, v1
    v_readfirstlane_b32 s28, v2
    s_waitcnt lgkmcnt(0)
    s_cmp_eq_u32 s28, 4
    s_cbranch_scc1 K1A_HELPER
    v_lshlrev_b32 v5, 5, v0
    global_load_dwordx4 v[8:11], v5, s[4:5]
    global_load_dwordx4 v[12:15], v5, s[4:5] offset:16
    s_lshl_b32 s29, s27, 7
    s_lshl_b32 s30, s28, 5
    s_add_u32 s29, s29, s30
    v_lshlrev_b32 v6, 3, v3
    v_add_u32 v6, s29, v6
    v_lshlrev_b32 v7, 13, v6
    s_lshl_b32 s30, s22, 10
    s_lshl_b32 s31, s26, 7
    s_add_u32 s30, s30, s31
    v_lshlrev_b32 v16, 3, v4
    v_add_u32 v7, v7, v16
    v_add_u32 v7, s30, v7
    global_load_dwordx2 v[16:17], v7, s[10:11]
    v_add_u32 v7, 0x2000, v7
    global_load_dwordx2 v[18:19], v7, s[10:11]
    v_add_u32 v7, 0x2000, v7
    global_load_dwordx2 v[20:21], v7, s[10:11]
    v_add_u32 v7, 0x2000, v7
    global_load_dwordx2 v[22:23], v7, s[10:11]
    v_add_u32 v7, 0x2000, v7
    global_load_dwordx2 v[24:25], v7, s[10:11]
    v_add_u32 v7, 0x2000, v7
    global_load_dwordx2 v[26:27], v7, s[10:11]
    v_add_u32 v7, 0x2000, v7
    global_load_dwordx2 v[28:29], v7, s[10:11]
    v_add_u32 v7, 0x2000, v7
    global_load_dwordx2 v[30:31], v7, s[10:11]
    s_cmp_lt_u32 s2, 112
    s_cbranch_scc0 K1A_NOW1
    s_and_b32 s33, s2, 3
    s_lshr_b32 s34, s2, 2
    s_lshl_b32 s29, s33, 7
    s_lshl_b32 s30, s28, 5
    s_add_u32 s29, s29, s30
    v_lshlrev_b32 v6, 3, v3
    v_add_u32 v6, s29, v6
    s_movk_i32 s35, 3584
    v_mul_lo_u32 v7, v6, s35
    s_lshl_b32 s30, s34, 7
    v_lshlrev_b32 v6, 3, v4
    v_add_u32 v7, v7, v6
    v_add_u32 v7, s30, v7
    global_load_dwordx2 v[32:33], v7, s[12:13]
    v_add_u32 v7, 0xe00, v7
    global_load_dwordx2 v[34:35], v7, s[12:13]
    v_add_u32 v7, 0xe00, v7
    global_load_dwordx2 v[36:37], v7, s[12:13]
    v_add_u32 v7, 0xe00, v7
    global_load_dwordx2 v[38:39], v7, s[12:13]
    v_add_u32 v7, 0xe00, v7
    global_load_dwordx2 v[40:41], v7, s[12:13]
    v_add_u32 v7, 0xe00, v7
    global_load_dwordx2 v[42:43], v7, s[12:13]
    v_add_u32 v7, 0xe00, v7
    global_load_dwordx2 v[44:45], v7, s[12:13]
    v_add_u32 v7, 0xe00, v7
    global_load_dwordx2 v[46:47], v7, s[12:13]
K1A_NOW1:
    s_branch K1A_AFTERKV
    s_lshl_b32 s29, s24, 3
    s_add_u32 s29, s29, s22
    s_lshl_b32 s29, s29, 20
    s_lshl_b32 s30, s25, 16
    s_add_u32 s29, s29, s30
    s_lshl_b32 s30, s28, 14
    s_add_u32 s29, s29, s30
    s_add_u32 s29, s29, 0xc0000
    s_add_u32 s6, s6, s29
    s_addc_u32 s7, s7, 0
    s_add_u32 s8, s8, s29
    s_addc_u32 s9, s9, 0
    v_lshlrev_b32 v6, 8, v4
    v_lshlrev_b32 v7, 4, v3
    v_add_u32 v6, v6, v7
    global_load_dwordx4 v[64:67], v6, s[6:7] offset:0
    global_load_dwordx4 v[68:71], v6, s[6:7] offset:64
    global_load_dwordx4 v[72:75], v6, s[6:7] offset:128
    global_load_dwordx4 v[76:79], v6, s[6:7] offset:192
    v_add_u32 v6, 0x1000, v6
    global_load_dwordx4 v[80:83], v6, s[6:7] offset:0
    global_load_dwordx4 v[84:87], v6, s[6:7] offset:64
    global_load_dwordx4 v[88:91], v6, s[6:7] offset:128
    global_load_dwordx4 v[92:95], v6, s[6:7] offset:192
    v_add_u32 v6, 0x1000, v6
    global_load_dwordx4 v[96:99], v6, s[6:7] offset:0
    global_load_dwordx4 v[100:103], v6, s[6:7] offset:64
    global_load_dwordx4 v[104:107], v6, s[6:7] offset:128
    global_load_dwordx4 v[108:111], v6, s[6:7] offset:192
    v_add_u32 v6, 0x1000, v6
    global_load_dwordx4 v[112:115], v6, s[6:7] offset:0
    global_load_dwordx4 v[116:119], v6, s[6:7] offset:64
    global_load_dwordx4 v[120:123], v6, s[6:7] offset:128
    global_load_dwordx4 v[124:127], v6, s[6:7] offset:192
    v_lshlrev_b32 v6, 10, v3
    v_lshlrev_b32 v7, 4, v4
    v_add_u32 v6, v6, v7
    global_load_dwordx4 v[128:131], v6, s[8:9] offset:0
    global_load_dwordx4 v[132:135], v6, s[8:9] offset:256
    global_load_dwordx4 v[136:139], v6, s[8:9] offset:512
    global_load_dwordx4 v[140:143], v6, s[8:9] offset:768
    v_add_u32 v6, 0x1000, v6
    global_load_dwordx4 v[144:147], v6, s[8:9] offset:0
    global_load_dwordx4 v[148:151], v6, s[8:9] offset:256
    global_load_dwordx4 v[152:155], v6, s[8:9] offset:512
    global_load_dwordx4 v[156:159], v6, s[8:9] offset:768
    v_add_u32 v6, 0x1000, v6
    global_load_dwordx4 v[160:163], v6, s[8:9] offset:0
    global_load_dwordx4 v[164:167], v6, s[8:9] offset:256
    global_load_dwordx4 v[168:171], v6, s[8:9] offset:512
    global_load_dwordx4 v[172:175], v6, s[8:9] offset:768
    v_add_u32 v6, 0x1000, v6
    global_load_dwordx4 v[176:179], v6, s[8:9] offset:0
    global_load_dwordx4 v[180:183], v6, s[8:9] offset:256
    global_load_dwordx4 v[184:187], v6, s[8:9] offset:512
    global_load_dwordx4 v[188:191], v6, s[8:9] offset:768
K1A_AFTERKV:
    s_cmp_lt_u32 s2, 112
    s_cbranch_scc0 K1A_WX2
    s_waitcnt vmcnt(16)
    s_branch K1A_WX3
K1A_WX2:
    s_waitcnt vmcnt(8)
K1A_WX3:
    v_lshlrev_b32 v192, 16, v8
    v_and_b32 v193, 0xffff0000, v8
    v_lshlrev_b32 v194, 16, v9
    v_and_b32 v195, 0xffff0000, v9
    v_lshlrev_b32 v196, 16, v10
    v_and_b32 v197, 0xffff0000, v10
    v_lshlrev_b32 v198, 16, v11
    v_and_b32 v199, 0xffff0000, v11
    v_lshlrev_b32 v200, 16, v12
    v_and_b32 v201, 0xffff0000, v12
    v_lshlrev_b32 v202, 16, v13
    v_and_b32 v203, 0xffff0000, v13
    v_lshlrev_b32 v204, 16, v14
    v_and_b32 v205, 0xffff0000, v14
    v_lshlrev_b32 v206, 16, v15
    v_and_b32 v207, 0xffff0000, v15
    v_add_f32 v208, v192, v193
    v_add_f32 v208, v208, v194
    v_add_f32 v208, v208, v195
    v_add_f32 v208, v208, v196
    v_add_f32 v208, v208, v197
    v_add_f32 v208, v208, v198
    v_add_f32 v208, v208, v199
    v_add_f32 v208, v208, v200
    v_add_f32 v208, v208, v201
    v_add_f32 v208, v208, v202
    v_add_f32 v208, v208, v203
    v_add_f32 v208, v208, v204
    v_add_f32 v208, v208, v205
    v_add_f32 v208, v208, v206
    v_add_f32 v208, v208, v207
    ds_swizzle_b32 v209, v208 offset:1055
    s_waitcnt lgkmcnt(0)
    v_add_f32 v208, v208, v209
    ds_swizzle_b32 v209, v208 offset:2079
    s_waitcnt lgkmcnt(0)
    v_add_f32 v208, v208, v209
    ds_swizzle_b32 v209, v208 offset:4127
    s_waitcnt lgkmcnt(0)
    v_add_f32 v208, v208, v209
    ds_swizzle_b32 v209, v208 offset:8223
    s_waitcnt lgkmcnt(0)
    v_add_f32 v208, v208, v209
    ds_swizzle_b32 v209, v208 offset:16415
    s_waitcnt lgkmcnt(0)
    v_add_f32 v208, v208, v209
    v_mul_f32 v208, 0x3b000000, v208
    v_sub_f32 v192, v192, v208
    v_sub_f32 v193, v193, v208
    v_sub_f32 v194, v194, v208
    v_sub_f32 v195, v195, v208
    v_sub_f32 v196, v196, v208
    v_sub_f32 v197, v197, v208
    v_sub_f32 v198, v198, v208
    v_sub_f32 v199, v199, v208
    v_sub_f32 v200, v200, v208
    v_sub_f32 v201, v201, v208
    v_sub_f32 v202, v202, v208
    v_sub_f32 v203, v203, v208
    v_sub_f32 v204, v204, v208
    v_sub_f32 v205, v205, v208
    v_sub_f32 v206, v206, v208
    v_sub_f32 v207, v207, v208
    v_mul_f32 v210, v192, v192
    v_fmac_f32 v210, v193, v193
    v_fmac_f32 v210, v194, v194
    v_fmac_f32 v210, v195, v195
    v_fmac_f32 v210, v196, v196
    v_fmac_f32 v210, v197, v197
    v_fmac_f32 v210, v198, v198
    v_fmac_f32 v210, v199, v199
    v_fmac_f32 v210, v200, v200
    v_fmac_f32 v210, v201, v201
    v_fmac_f32 v210, v202, v202
    v_fmac_f32 v210, v203, v203
    v_fmac_f32 v210, v204, v204
    v_fmac_f32 v210, v205, v205
    v_fmac_f32 v210, v206, v206
    v_fmac_f32 v210, v207, v207
    ds_swizzle_b32 v209, v210 offset:1055
    s_waitcnt lgkmcnt(0)
    v_add_f32 v210, v210, v209
    ds_swizzle_b32 v209, v210 offset:2079
    s_waitcnt lgkmcnt(0)
    v_add_f32 v210, v210, v209
    ds_swizzle_b32 v209, v210 offset:4127
    s_waitcnt lgkmcnt(0)
    v_add_f32 v210, v210, v209
    ds_swizzle_b32 v209, v210 offset:8223
    s_waitcnt lgkmcnt(0)
    v_add_f32 v210, v210, v209
    ds_swizzle_b32 v209, v210 offset:16415
    s_waitcnt lgkmcnt(0)
    v_add_f32 v210, v210, v209
    v_mov_b32 v211, 0x3727c5ac
    v_fmac_f32 v211, 0x3b000000, v210
    v_rsq_f32 v211, v211
    s_nop 0
    v_mul_f32 v192, v192, v211
    v_mul_f32 v193, v193, v211
    v_mul_f32 v194, v194, v211
    v_mul_f32 v195, v195, v211
    v_mul_f32 v196, v196, v211
    v_mul_f32 v197, v197, v211
    v_mul_f32 v198, v198, v211
    v_mul_f32 v199, v199, v211
    v_mul_f32 v200, v200, v211
    v_mul_f32 v201, v201, v211
    v_mul_f32 v202, v202, v211
    v_mul_f32 v203, v203, v211
    v_mul_f32 v204, v204, v211
    v_mul_f32 v205, v205, v211
    v_mul_f32 v206, v206, v211
    v_mul_f32 v207, v207, v211
    v_cvt_pk_bf16_f32 v8, v192, v193
    v_cvt_pk_bf16_f32 v9, v194, v195
    v_cvt_pk_bf16_f32 v10, v196, v197
    v_cvt_pk_bf16_f32 v11, v198, v199
    v_cvt_pk_bf16_f32 v12, v200, v201
    v_cvt_pk_bf16_f32 v13, v202, v203
    v_cvt_pk_bf16_f32 v14, v204, v205
    v_cvt_pk_bf16_f32 v15, v206, v207
    v_lshrrev_b32 v5, 5, v0
    v_mul_u32_u24 v5, 1040, v5
    v_and_b32 v6, 31, v0
    v_lshlrev_b32 v6, 5, v6
    v_add_u32 v5, v5, v6
    ds_write_b128 v5, v[8:11] offset:0
    ds_write_b128 v5, v[12:15] offset:16
    s_waitcnt lgkmcnt(0)
    s_barrier
    v_and_b32 v5, 7, v4
    v_mul_u32_u24 v5, 1040, v5
    v_lshlrev_b32 v6, 4, v3
    v_add_u32 v5, v5, v6
    s_lshl_b32 s29, s28, 6
    v_add_u32 v5, s29, v5
    s_lshl_b32 s30, s27, 8
    v_add_u32 v6, s30, v5
    ds_read_b128 v[192:195], v6 offset:0
    s_cmp_lt_u32 s2, 112
    s_cbranch_scc0 K1A_WQ2
    s_waitcnt vmcnt(8) lgkmcnt(0)
    s_branch K1A_WQ3
K1A_WQ2:
    s_waitcnt vmcnt(0) lgkmcnt(0)
K1A_WQ3:
    v_perm_b32 v196, v18, v16, s20
    v_perm_b32 v197, v22, v20, s20
    v_perm_b32 v198, v26, v24, s20
    v_perm_b32 v199, v30, v28, s20
    s_nop 1
    v_mfma_f32_16x16x32_bf16 v[200:203], v[192:195], v[196:199], 0
    s_nop 3
    v_perm_b32 v196, v18, v16, s21
    v_perm_b32 v197, v22, v20, s21
    v_perm_b32 v198, v26, v24, s21
    v_perm_b32 v199, v30, v28, s21
    s_nop 1
    v_mfma_f32_16x16x32_bf16 v[204:207], v[192:195], v[196:199], 0
    s_nop 3
    v_perm_b32 v196, v19, v17, s20
    v_perm_b32 v197, v23, v21, s20
    v_perm_b32 v198, v27, v25, s20
    v_perm_b32 v199, v31, v29, s20
    s_nop 1
    v_mfma_f32_16x16x32_bf16 v[208:211], v[192:195], v[196:199], 0
    s_nop 3
    v_perm_b32 v196, v19, v17, s21
    v_perm_b32 v197, v23, v21, s21
    v_perm_b32 v198, v27, v25, s21
    v_perm_b32 v199, v31, v29, s21
    s_nop 1
    v_mfma_f32_16x16x32_bf16 v[212:215], v[192:195], v[196:199], 0
    s_nop 3
    s_nop 7
    v_lshlrev_b32 v7, 10, v3
    v_lshlrev_b32 v6, 4, v4
    v_add_u32 v7, v7, v6
    s_lshl_b32 s29, s28, 11
    v_add_u32 v7, s29, v7
    v_cmp_gt_u32 vcc, 32, v1
    s_and_saveexec_b64 s[36:37], vcc
    ds_write_b32 v7, v200 offset:8448
    ds_write_b32 v7, v204 offset:8452
    ds_write_b32 v7, v208 offset:8456
    ds_write_b32 v7, v212 offset:8460
    ds_write_b32 v7, v201 offset:8704
    ds_write_b32 v7, v205 offset:8708
    ds_write_b32 v7, v209 offset:8712
    ds_write_b32 v7, v213 offset:8716
    ds_write_b32 v7, v202 offset:8960
    ds_write_b32 v7, v206 offset:8964
    ds_write_b32 v7, v210 offset:8968
    ds_write_b32 v7, v214 offset:8972
    ds_write_b32 v7, v203 offset:9216
    ds_write_b32 v7, v207 offset:9220
    ds_write_b32 v7, v211 offset:9224
    ds_write_b32 v7, v215 offset:9228
    s_mov_b64 exec, s[36:37]
    s_cmp_lt_u32 s2, 112
    s_cbranch_scc0 K1A_NOH
    s_lshl_b32 s30, s33, 8
    v_add_u32 v6, s30, v5
    ds_read_b128 v[192:195], v6 offset:0
    s_waitcnt vmcnt(0) lgkmcnt(0)
    v_perm_b32 v196, v34, v32, s20
    v_perm_b32 v197, v38, v36, s20
    v_perm_b32 v198, v42, v40, s20
    v_perm_b32 v199, v46, v44, s20
    s_nop 1
    v_mfma_f32_16x16x32_bf16 v[200:203], v[192:195], v[196:199], 0
    s_nop 3
    v_perm_b32 v196, v34, v32, s21
    v_perm_b32 v197, v38, v36, s21
    v_perm_b32 v198, v42, v40, s21
    v_perm_b32 v199, v46, v44, s21
    s_nop 1
    v_mfma_f32_16x16x32_bf16 v[204:207], v[192:195], v[196:199], 0
    s_nop 3
    v_perm_b32 v196, v35, v33, s20
    v_perm_b32 v197, v39, v37, s20
    v_perm_b32 v198, v43, v41, s20
    v_perm_b32 v199, v47, v45, s20
    s_nop 1
    v_mfma_f32_16x16x32_bf16 v[208:211], v[192:195], v[196:199], 0
    s_nop 3
    v_perm_b32 v196, v35, v33, s21
    v_perm_b32 v197, v39, v37, s21
    v_perm_b32 v198, v43, v41, s21
    v_perm_b32 v199, v47, v45, s21
    s_nop 1
    v_mfma_f32_16x16x32_bf16 v[212:215], v[192:195], v[196:199], 0
    s_nop 3
    s_nop 7
    s_and_saveexec_b64 s[36:37], vcc
    ds_write_b32 v7, v200 offset:16640
    ds_write_b32 v7, v204 offset:16644
    ds_write_b32 v7, v208 offset:16648
    ds_write_b32 v7, v212 offset:16652
    ds_write_b32 v7, v201 offset:16896
    ds_write_b32 v7, v205 offset:16900
    ds_write_b32 v7, v209 offset:16904
    ds_write_b32 v7, v213 offset:16908
    ds_write_b32 v7, v202 offset:17152
    ds_write_b32 v7, v206 offset:17156
    ds_write_b32 v7, v210 offset:17160
    ds_write_b32 v7, v214 offset:17164
    ds_write_b32 v7, v203 offset:17408
    ds_write_b32 v7, v207 offset:17412
    ds_write_b32 v7, v211 offset:17416
    ds_write_b32 v7, v215 offset:17420
    s_mov_b64 exec, s[36:37]
K1A_NOH:
    s_waitcnt lgkmcnt(0)
    s_barrier
    s_endpgm
    s_barrier
    v_and_b32 v5, 3, v4
    v_mul_u32_u24 v5, 272, v5
    v_lshlrev_b32 v6, 4, v3
    v_add_u32 v5, v5, v6
    ds_read_b128 v[8:11], v5 offset:24832
    ds_read_b128 v[12:15], v5 offset:24896
    ds_read_b128 v[16:19], v5 offset:24960
    ds_read_b128 v[20:23], v5 offset:25024
    s_waitcnt vmcnt(16) lgkmcnt(0)
    v_mfma_f32_16x16x32_bf16 v[24:27], v[64:67], v[8:11], 0
    v_mfma_f32_16x16x32_bf16 v[24:27], v[68:71], v[12:15], v[24:27]
    v_mfma_f32_16x16x32_bf16 v[24:27], v[72:75], v[16:19], v[24:27]
    v_mfma_f32_16x16x32_bf16 v[24:27], v[76:79], v[20:23], v[24:27]
    v_mfma_f32_16x16x32_bf16 v[28:31], v[80:83], v[8:11], 0
    v_mfma_f32_16x16x32_bf16 v[28:31], v[84:87], v[12:15], v[28:31]
    v_mfma_f32_16x16x32_bf16 v[28:31], v[88:91], v[16:19], v[28:31]
    v_mfma_f32_16x16x32_bf16 v[28:31], v[92:95], v[20:23], v[28:31]
    v_mfma_f32_16x16x32_bf16 v[32:35], v[96:99], v[8:11], 0
    v_mfma_f32_16x16x32_bf16 v[32:35], v[100:103], v[12:15], v[32:35]
    v_mfma_f32_16x16x32_bf16 v[32:35], v[104:107], v[16:19], v[32:35]
    v_mfma_f32_16x16x32_bf16 v[32:35], v[108:111], v[20:23], v[32:35]
    v_mfma_f32_16x16x32_bf16 v[36:39], v[112:115], v[8:11], 0
    v_mfma_f32_16x16x32_bf16 v[36:39], v[116:119], v[12:15], v[36:39]
    v_mfma_f32_16x16x32_bf16 v[36:39], v[120:123], v[16:19], v[36:39]
    v_mfma_f32_16x16x32_bf16 v[36:39], v[124:127], v[20:23], v[36:39]
    s_nop 9
    v_max_f32 v40, v24, v25
    v_max_f32 v40, v40, v26
    v_max_f32 v40, v40, v27
    v_max_f32 v40, v40, v28
    v_max_f32 v40, v40, v29
    v_max_f32 v40, v40, v30
    v_max_f32 v40, v40, v31
    v_max_f32 v40, v40, v32
    v_max_f32 v40, v40, v33
    v_max_f32 v40, v40, v34
    v_max_f32 v40, v40, v35
    v_max_f32 v40, v40, v36
    v_max_f32 v40, v40, v37
    v_max_f32 v40, v40, v38
    v_max_f32 v40, v40, v39
    v_lshlrev_b32 v41, 2, v1
    v_xor_b32 v42, 64, v41
    v_xor_b32 v43, 128, v41
    ds_bpermute_b32 v44, v42, v40
    s_waitcnt lgkmcnt(0)
    v_max_f32 v40, v40, v44
    ds_bpermute_b32 v44, v43, v40
    s_waitcnt lgkmcnt(0)
    v_max_f32 v40, v40, v44
    v_mov_b32 v45, 0x3e0293ee
    v_mul_f32 v46, v40, v45
    v_fma_f32 v24, v24, v45, -v46
    v_fma_f32 v25, v25, v45, -v46
    v_fma_f32 v26, v26, v45, -v46
    v_fma_f32 v27, v27, v45, -v46
    v_fma_f32 v28, v28, v45, -v46
    v_fma_f32 v29, v29, v45, -v46
    v_fma_f32 v30, v30, v45, -v46
    v_fma_f32 v31, v31, v45, -v46
    v_fma_f32 v32, v32, v45, -v46
    v_fma_f32 v33, v33, v45, -v46
    v_fma_f32 v34, v34, v45, -v46
    v_fma_f32 v35, v35, v45, -v46
    v_fma_f32 v36, v36, v45, -v46
    v_fma_f32 v37, v37, v45, -v46
    v_fma_f32 v38, v38, v45, -v46
    v_fma_f32 v39, v39, v45, -v46
    v_exp_f32 v24, v24
    v_exp_f32 v25, v25
    v_exp_f32 v26, v26
    v_exp_f32 v27, v27
    v_exp_f32 v28, v28
    v_exp_f32 v29, v29
    v_exp_f32 v30, v30
    v_exp_f32 v31, v31
    v_exp_f32 v32, v32
    v_exp_f32 v33, v33
    v_exp_f32 v34, v34
    v_exp_f32 v35, v35
    v_exp_f32 v36, v36
    v_exp_f32 v37, v37
    v_exp_f32 v38, v38
    v_exp_f32 v39, v39
    s_nop 0
    v_add_f32 v47, v24, v25
    v_add_f32 v47, v47, v26
    v_add_f32 v47, v47, v27
    v_add_f32 v47, v47, v28
    v_add_f32 v47, v47, v29
    v_add_f32 v47, v47, v30
    v_add_f32 v47, v47, v31
    v_add_f32 v47, v47, v32
    v_add_f32 v47, v47, v33
    v_add_f32 v47, v47, v34
    v_add_f32 v47, v47, v35
    v_add_f32 v47, v47, v36
    v_add_f32 v47, v47, v37
    v_add_f32 v47, v47, v38
    v_add_f32 v47, v47, v39
    ds_bpermute_b32 v44, v42, v47
    s_waitcnt lgkmcnt(0)
    v_add_f32 v47, v47, v44
    ds_bpermute_b32 v44, v43, v47
    s_waitcnt lgkmcnt(0)
    v_add_f32 v47, v47, v44
    v_cvt_pk_bf16_f32 v48, v24, v25
    v_cvt_pk_bf16_f32 v49, v26, v27
    v_cvt_pk_bf16_f32 v50, v28, v29
    v_cvt_pk_bf16_f32 v51, v30, v31
    v_cvt_pk_bf16_f32 v52, v32, v33
    v_cvt_pk_bf16_f32 v53, v34, v35
    v_cvt_pk_bf16_f32 v54, v36, v37
    v_cvt_pk_bf16_f32 v55, v38, v39
    s_waitcnt vmcnt(0)
    v_perm_b32 v56, v132, v128, s20
    v_perm_b32 v57, v140, v136, s20
    v_perm_b32 v58, v148, v144, s20
    v_perm_b32 v59, v156, v152, s20
    s_nop 1
    v_mfma_f32_16x16x32_bf16 v[192:195], v[48:51], v[56:59], 0
    s_nop 3
    v_perm_b32 v56, v132, v128, s21
    v_perm_b32 v57, v140, v136, s21
    v_perm_b32 v58, v148, v144, s21
    v_perm_b32 v59, v156, v152, s21
    s_nop 1
    v_mfma_f32_16x16x32_bf16 v[196:199], v[48:51], v[56:59], 0
    s_nop 3
    v_perm_b32 v56, v133, v129, s20
    v_perm_b32 v57, v141, v137, s20
    v_perm_b32 v58, v149, v145, s20
    v_perm_b32 v59, v157, v153, s20
    s_nop 1
    v_mfma_f32_16x16x32_bf16 v[200:203], v[48:51], v[56:59], 0
    s_nop 3
    v_perm_b32 v56, v133, v129, s21
    v_perm_b32 v57, v141, v137, s21
    v_perm_b32 v58, v149, v145, s21
    v_perm_b32 v59, v157, v153, s21
    s_nop 1
    v_mfma_f32_16x16x32_bf16 v[204:207], v[48:51], v[56:59], 0
    s_nop 3
    v_perm_b32 v56, v134, v130, s20
    v_perm_b32 v57, v142, v138, s20
    v_perm_b32 v58, v150, v146, s20
    v_perm_b32 v59, v158, v154, s20
    s_nop 1
    v_mfma_f32_16x16x32_bf16 v[208:211], v[48:51], v[56:59], 0
    s_nop 3
    v_perm_b32 v56, v134, v130, s21
    v_perm_b32 v57, v142, v138, s21
    v_perm_b32 v58, v150, v146, s21
    v_perm_b32 v59, v158, v154, s21
    s_nop 1
    v_mfma_f32_16x16x32_bf16 v[212:215], v[48:51], v[56:59], 0
    s_nop 3
    v_perm_b32 v56, v135, v131, s20
    v_perm_b32 v57, v143, v139, s20
    v_perm_b32 v58, v151, v147, s20
    v_perm_b32 v59, v159, v155, s20
    s_nop 1
    v_mfma_f32_16x16x32_bf16 v[216:219], v[48:51], v[56:59], 0
    s_nop 3
    v_perm_b32 v56, v135, v131, s21
    v_perm_b32 v57, v143, v139, s21
    v_perm_b32 v58, v151, v147, s21
    v_perm_b32 v59, v159, v155, s21
    s_nop 1
    v_mfma_f32_16x16x32_bf16 v[220:223], v[48:51], v[56:59], 0
    s_nop 3
    v_perm_b32 v56, v164, v160, s20
    v_perm_b32 v57, v172, v168, s20
    v_perm_b32 v58, v180, v176, s20
    v_perm_b32 v59, v188, v184, s20
    s_nop 1
    v_mfma_f32_16x16x32_bf16 v[192:195], v[52:55], v[56:59], v[192:195]
    s_nop 3
    v_perm_b32 v56, v164, v160, s21
    v_perm_b32 v57, v172, v168, s21
    v_perm_b32 v58, v180, v176, s21
    v_perm_b32 v59, v188, v184, s21
    s_nop 1
    v_mfma_f32_16x16x32_bf16 v[196:199], v[52:55], v[56:59], v[196:199]
    s_nop 3
    v_perm_b32 v56, v165, v161, s20
    v_perm_b32 v57, v173, v169, s20
    v_perm_b32 v58, v181, v177, s20
    v_perm_b32 v59, v189, v185, s20
    s_nop 1
    v_mfma_f32_16x16x32_bf16 v[200:203], v[52:55], v[56:59], v[200:203]
    s_nop 3
    v_perm_b32 v56, v165, v161, s21
    v_perm_b32 v57, v173, v169, s21
    v_perm_b32 v58, v181, v177, s21
    v_perm_b32 v59, v189, v185, s21
    s_nop 1
    v_mfma_f32_16x16x32_bf16 v[204:207], v[52:55], v[56:59], v[204:207]
    s_nop 3
    v_perm_b32 v56, v166, v162, s20
    v_perm_b32 v57, v174, v170, s20
    v_perm_b32 v58, v182, v178, s20
    v_perm_b32 v59, v190, v186, s20
    s_nop 1
    v_mfma_f32_16x16x32_bf16 v[208:211], v[52:55], v[56:59], v[208:211]
    s_nop 3
    v_perm_b32 v56, v166, v162, s21
    v_perm_b32 v57, v174, v170, s21
    v_perm_b32 v58, v182, v178, s21
    v_perm_b32 v59, v190, v186, s21
    s_nop 1
    v_mfma_f32_16x16x32_bf16 v[212:215], v[52:55], v[56:59], v[212:215]
    s_nop 3
    v_perm_b32 v56, v167, v163, s20
    v_perm_b32 v57, v175, v171, s20
    v_perm_b32 v58, v183, v179, s20
    v_perm_b32 v59, v191, v187, s20
    s_nop 1
    v_mfma_f32_16x16x32_bf16 v[216:219], v[52:55], v[56:59], v[216:219]
    s_nop 3
    v_perm_b32 v56, v167, v163, s21
    v_perm_b32 v57, v175, v171, s21
    v_perm_b32 v58, v183, v179, s21
    v_perm_b32 v59, v191, v187, s21
    s_nop 1
    v_mfma_f32_16x16x32_bf16 v[220:223], v[52:55], v[56:59], v[220:223]
    s_nop 3
    s_nop 9
    v_lshlrev_b32 v5, 5, v1
    s_lshl_b32 s29, s28, 11
    v_add_u32 v5, s29, v5
    v_cmp_gt_u32 vcc, 16, v1
    s_and_saveexec_b64 s[36:37], vcc
    ds_write_b32 v5, v192 offset:25984
    ds_write_b32 v5, v196 offset:25988
    ds_write_b32 v5, v200 offset:25992
    ds_write_b32 v5, v204 offset:25996
    ds_write_b32 v5, v208 offset:26000
    ds_write_b32 v5, v212 offset:26004
    ds_write_b32 v5, v216 offset:26008
    ds_write_b32 v5, v220 offset:26012
    ds_write_b32 v5, v193 offset:26496
    ds_write_b32 v5, v197 offset:26500
    ds_write_b32 v5, v201 offset:26504
    ds_write_b32 v5, v205 offset:26508
    ds_write_b32 v5, v209 offset:26512
    ds_write_b32 v5, v213 offset:26516
    ds_write_b32 v5, v217 offset:26520
    ds_write_b32 v5, v221 offset:26524
    ds_write_b32 v5, v194 offset:27008
    ds_write_b32 v5, v198 offset:27012
    ds_write_b32 v5, v202 offset:27016
    ds_write_b32 v5, v206 offset:27020
    ds_write_b32 v5, v210 offset:27024
    ds_write_b32 v5, v214 offset:27028
    ds_write_b32 v5, v218 offset:27032
    ds_write_b32 v5, v222 offset:27036
    ds_write_b32 v5, v195 offset:27520
    ds_write_b32 v5, v199 offset:27524
    ds_write_b32 v5, v203 offset:27528
    ds_write_b32 v5, v207 offset:27532
    ds_write_b32 v5, v211 offset:27536
    ds_write_b32 v5, v215 offset:27540
    ds_write_b32 v5, v219 offset:27544
    ds_write_b32 v5, v223 offset:27548
    v_cmp_gt_u32 vcc, 4, v1
    s_and_b64 exec, exec, vcc
    v_lshlrev_b32 v5, 3, v1
    s_lshl_b32 s29, s28, 5
    v_add_u32 v5, s29, v5
    v_mov_b32 v49, v47
    v_mov_b32 v48, v40
    ds_write_b64 v5, v[48:49] offset:34176
    s_mov_b64 exec, s[36:37]
    s_waitcnt lgkmcnt(0)
    s_barrier
    s_cmp_ge_u32 s28, 2
    s_cbranch_scc1 K1A_END
    v_lshrrev_b32 v5, 5, v0
    v_lshlrev_b32 v6, 3, v5
    ds_read_b64 v[8:9], v6 offset:34176
    ds_read_b64 v[10:11], v6 offset:34208
    ds_read_b64 v[12:13], v6 offset:34240
    ds_read_b64 v[14:15], v6 offset:34272
    v_lshlrev_b32 v7, 9, v5
    v_and_b32 v16, 31, v0
    v_lshlrev_b32 v16, 4, v16
    v_add_u32 v7, v7, v16
    ds_read_b128 v[20:23], v7 offset:25984
    ds_read_b128 v[24:27], v7 offset:28032
    ds_read_b128 v[28:31], v7 offset:30080
    ds_read_b128 v[32:35], v7 offset:32128
    s_waitcnt lgkmcnt(0)
    v_max_f32 v17, v8, v10
    v_max3_f32 v17, v17, v12, v14
    v_mov_b32 v45, 0x3e0293ee
    v_sub_f32 v36, v8, v17
    v_mul_f32 v36, v36, v45
    v_sub_f32 v37, v10, v17
    v_mul_f32 v37, v37, v45
    v_sub_f32 v38, v12, v17
    v_mul_f32 v38, v38, v45
    v_sub_f32 v39, v14, v17
    v_mul_f32 v39, v39, v45
    v_exp_f32 v36, v36
    v_exp_f32 v37, v37
    v_exp_f32 v38, v38
    v_exp_f32 v39, v39
    s_nop 0
    v_mul_f32 v19, v9, v36
    v_fmac_f32 v19, v11, v37
    v_fmac_f32 v19, v13, v38
    v_fmac_f32 v19, v15, v39
    v_mul_f32 v40, v20, v36
    v_fmac_f32 v40, v24, v37
    v_fmac_f32 v40, v28, v38
    v_fmac_f32 v40, v32, v39
    v_mul_f32 v41, v21, v36
    v_fmac_f32 v41, v25, v37
    v_fmac_f32 v41, v29, v38
    v_fmac_f32 v41, v33, v39
    v_mul_f32 v42, v22, v36
    v_fmac_f32 v42, v26, v37
    v_fmac_f32 v42, v30, v38
    v_fmac_f32 v42, v34, v39
    v_mul_f32 v43, v23, v36
    v_fmac_f32 v43, v27, v37
    v_fmac_f32 v43, v31, v38
    v_fmac_f32 v43, v35, v39
    v_mov_b32 v18, v17
    s_lshl_b32 s29, s24, 5
    s_lshl_b32 s30, s22, 2
    s_add_u32 s29, s29, s30
    s_lshl_b32 s29, s29, 2
    s_add_u32 s29, s29, s25
    v_lshlrev_b32 v6, 2, v5
    v_add_u32 v6, s29, v6
    v_lshlrev_b32 v7, 9, v6
    v_add_u32 v7, v7, v16
    v_add_u32 v7, 0x100000, v7
    global_store_dwordx4 v7, v[40:43], s[18:19]
    v_lshlrev_b32 v7, 3, v6
    v_add_u32 v7, 0x180000, v7
    v_and_b32 v16, 31, v0
    v_cmp_eq_u32 vcc, 0, v16
    s_and_saveexec_b64 s[36:37], vcc
    global_store_dwordx2 v7, v[18:19], s[18:19]
    s_endpgm
K1A_HELPER:
    s_lshl_b32 s29, s2, 6
    v_lshlrev_b32 v5, 2, v1
    v_add_u32 v5, s29, v5
    v_add_u32 v5, 0x190000, v5
    v_mov_b32 v6, 0
    v_cmp_gt_u32 vcc, 16, v1
    s_and_saveexec_b64 s[36:37], vcc
    global_store_dword v5, v6, s[18:19]
    s_mov_b64 exec, s[36:37]
    s_barrier
    s_barrier
    v_lshlrev_b32 v5, 5, v1
    ds_read_b128 v[8:11], v5 offset:8448
    ds_read_b128 v[12:15], v5 offset:8464
    ds_read_b128 v[16:19], v5 offset:10496
    ds_read_b128 v[20:23], v5 offset:10512
    ds_read_b128 v[24:27], v5 offset:12544
    ds_read_b128 v[28:31], v5 offset:12560
    ds_read_b128 v[32:35], v5 offset:14592
    ds_read_b128 v[36:39], v5 offset:14608
    s_waitcnt lgkmcnt(0)
    v_add_f32 v8, v8, v16
    v_add_f32 v24, v24, v32
    v_add_f32 v8, v8, v24
    v_add_f32 v9, v9, v17
    v_add_f32 v25, v25, v33
    v_add_f32 v9, v9, v25
    v_add_f32 v10, v10, v18
    v_add_f32 v26, v26, v34
    v_add_f32 v10, v10, v26
    v_add_f32 v11, v11, v19
    v_add_f32 v27, v27, v35
    v_add_f32 v11, v11, v27
    v_add_f32 v12, v12, v20
    v_add_f32 v28, v28, v36
    v_add_f32 v12, v12, v28
    v_add_f32 v13, v13, v21
    v_add_f32 v29, v29, v37
    v_add_f32 v13, v13, v29
    v_add_f32 v14, v14, v22
    v_add_f32 v30, v30, v38
    v_add_f32 v14, v14, v30
    v_add_f32 v15, v15, v23
    v_add_f32 v31, v31, v39
    v_add_f32 v15, v15, v31
    s_lshl_b32 s29, s22, 2
    s_add_u32 s29, s29, s27
    s_lshl_b32 s29, s29, 14
    s_lshl_b32 s30, s26, 8
    s_add_u32 s29, s29, s30
    v_lshrrev_b32 v6, 3, v1
    v_lshlrev_b32 v6, 11, v6
    v_and_b32 v7, 7, v1
    v_lshlrev_b32 v7, 5, v7
    v_add_u32 v6, v6, v7
    v_add_u32 v6, s29, v6
    global_store_dwordx4 v6, v[8:11], s[18:19]
    global_store_dwordx4 v6, v[12:15], s[18:19] offset:16
    s_cmp_lt_u32 s2, 112
    s_cbranch_scc0 K1A_H_NOH
    ds_read_b128 v[8:11], v5 offset:16640
    ds_read_b128 v[12:15], v5 offset:16656
    ds_read_b128 v[16:19], v5 offset:18688
    ds_read_b128 v[20:23], v5 offset:18704
    ds_read_b128 v[24:27], v5 offset:20736
    ds_read_b128 v[28:31], v5 offset:20752
    ds_read_b128 v[32:35], v5 offset:22784
    ds_read_b128 v[36:39], v5 offset:22800
    s_waitcnt lgkmcnt(0)
    v_add_f32 v8, v8, v16
    v_add_f32 v24, v24, v32
    v_add_f32 v8, v8, v24
    v_add_f32 v9, v9, v17
    v_add_f32 v25, v25, v33
    v_add_f32 v9, v9, v25
    v_add_f32 v10, v10, v18
    v_add_f32 v26, v26, v34
    v_add_f32 v10, v10, v26
    v_add_f32 v11, v11, v19
    v_add_f32 v27, v27, v35
    v_add_f32 v11, v11, v27
    v_add_f32 v12, v12, v20
    v_add_f32 v28, v28, v36
    v_add_f32 v12, v12, v28
    v_add_f32 v13, v13, v21
    v_add_f32 v29, v29, v37
    v_add_f32 v13, v13, v29
    v_add_f32 v14, v14, v22
    v_add_f32 v30, v30, v38
    v_add_f32 v14, v14, v30
    v_add_f32 v15, v15, v23
    v_add_f32 v31, v31, v39
    v_add_f32 v15, v15, v31
    s_and_b32 s33, s2, 3
    s_lshr_b32 s34, s2, 2
    s_mul_i32 s29, s33, 57344
    s_lshl_b32 s30, s34, 8
    s_add_u32 s29, s29, s30
    s_add_u32 s29, s29, 0x80000
    v_lshrrev_b32 v6, 3, v1
    v_mul_u32_u24 v6, 7168, v6
    v_add_u32 v6, v6, v7
    v_add_u32 v6, s29, v6
    global_store_dwordx4 v6, v[8:11], s[18:19]
    global_store_dwordx4 v6, v[12:15], s[18:19] offset:16
K1A_H_NOH:
    s_waitcnt vmcnt(0)
    s_endpgm
    s_lshl_b32 s29, s22, 5
    v_mov_b32 v5, s29
    v_mov_b32 v6, 1
    v_cmp_eq_u32 vcc, 0, v1
    s_and_saveexec_b64 s[36:37], vcc
    global_atomic_add v5, v6, s[16:17]
    s_mov_b64 exec, s[36:37]
    s_mov_b32 s38, 200000
K1A_POLL:
    global_load_dword v6, v5, s[16:17]
    s_waitcnt vmcnt(0)
    v_readfirstlane_b32 s39, v6
    s_cmp_ge_u32 s39, 32
    s_cbranch_scc1 K1A_POLLED
    s_sleep 2
    s_sub_u32 s38, s38, 1
    s_cmp_lg_u32 s38, 0
    s_cbranch_scc1 K1A_POLL
K1A_POLLED:
    s_lshl_b32 s29, s22, 16
    s_lshl_b32 s30, s24, 11
    s_add_u32 s29, s29, s30
    v_lshlrev_b32 v5, 5, v1
    v_add_u32 v5, s29, v5
    global_load_dwordx4 v[8:11], v5, s[18:19]
    global_load_dwordx4 v[12:15], v5, s[18:19] offset:16
    v_add_u32 v5, 0x4000, v5
    global_load_dwordx4 v[16:19], v5, s[18:19]
    global_load_dwordx4 v[20:23], v5, s[18:19] offset:16
    v_add_u32 v5, 0x4000, v5
    global_load_dwordx4 v[24:27], v5, s[18:19]
    global_load_dwordx4 v[28:31], v5, s[18:19] offset:16
    v_add_u32 v5, 0x4000, v5
    global_load_dwordx4 v[32:35], v5, s[18:19]
    global_load_dwordx4 v[36:39], v5, s[18:19] offset:16
    s_waitcnt vmcnt(0)
    v_add_f32 v8, v8, v16
    v_add_f32 v24, v24, v32
    v_add_f32 v8, v8, v24
    v_add_f32 v9, v9, v17
    v_add_f32 v25, v25, v33
    v_add_f32 v9, v9, v25
    v_add_f32 v10, v10, v18
    v_add_f32 v26, v26, v34
    v_add_f32 v10, v10, v26
    v_add_f32 v11, v11, v19
    v_add_f32 v27, v27, v35
    v_add_f32 v11, v11, v27
    v_add_f32 v12, v12, v20
    v_add_f32 v28, v28, v36
    v_add_f32 v12, v12, v28
    v_add_f32 v13, v13, v21
    v_add_f32 v29, v29, v37
    v_add_f32 v13, v13, v29
    v_add_f32 v14, v14, v22
    v_add_f32 v30, v30, v38
    v_add_f32 v14, v14, v30
    v_add_f32 v15, v15, v23
    v_add_f32 v31, v31, v39
    v_add_f32 v15, v15, v31
    v_cvt_pk_bf16_f32 v40, v8, v9
    v_cvt_pk_bf16_f32 v41, v10, v11
    v_cvt_pk_bf16_f32 v42, v12, v13
    v_cvt_pk_bf16_f32 v43, v14, v15
    v_mul_u32_u24 v5, 272, v3
    v_lshlrev_b32 v6, 4, v4
    v_add_u32 v5, v5, v6
    ds_write_b128 v5, v[40:43] offset:24832
    s_waitcnt lgkmcnt(0)
    s_barrier
    s_barrier
K1A_END:
    s_endpgm
.globl k1_attn_kernel
.p2align 8
.type k1_attn_kernel,@function
k1_attn_kernel:
    s_cmp_ge_u32 s2, 256
    s_cbranch_scc1 K1B_END
    s_load_dwordx4 s[4:7], s[0:1], 0
    s_load_dwordx4 s[8:11], s[0:1], 16
    s_load_dwordx2 s[12:13], s[0:1], 48
    s_load_dwordx4 s[16:19], s[0:1], 88
    s_mov_b32 s20, 0x05040100
    s_mov_b32 s21, 0x07060302
    s_lshr_b32 s22, s2, 5
    s_and_b32 s23, s2, 31
    s_lshr_b32 s24, s23, 2
    s_and_b32 s25, s23, 3
    s_and_b32 s26, s23, 7
    s_lshr_b32 s27, s23, 3
    v_and_b32 v1, 63, v0
    v_lshrrev_b32 v2, 6, v0
    v_lshrrev_b32 v3, 4, v1
    v_and_b32 v4, 15, v1
    v_readfirstlane_b32 s28, v2
    s_waitcnt lgkmcnt(0)
    s_cmp_eq_u32 s28, 4
    s_cbranch_scc1 K1B_HELPER
    s_branch K1B_NOW1
    v_lshlrev_b32 v5, 5, v0
    global_load_dwordx4 v[8:11], v5, s[4:5]
    global_load_dwordx4 v[12:15], v5, s[4:5] offset:16
    s_lshl_b32 s29, s27, 7
    s_lshl_b32 s30, s28, 5
    s_add_u32 s29, s29, s30
    v_lshlrev_b32 v6, 3, v3
    v_add_u32 v6, s29, v6
    v_lshlrev_b32 v7, 13, v6
    s_lshl_b32 s30, s22, 10
    s_lshl_b32 s31, s26, 7
    s_add_u32 s30, s30, s31
    v_lshlrev_b32 v16, 3, v4
    v_add_u32 v7, v7, v16
    v_add_u32 v7, s30, v7
    global_load_dwordx2 v[16:17], v7, s[10:11]
    v_add_u32 v7, 0x2000, v7
    global_load_dwordx2 v[18:19], v7, s[10:11]
    v_add_u32 v7, 0x2000, v7
    global_load_dwordx2 v[20:21], v7, s[10:11]
    v_add_u32 v7, 0x2000, v7
    global_load_dwordx2 v[22:23], v7, s[10:11]
    v_add_u32 v7, 0x2000, v7
    global_load_dwordx2 v[24:25], v7, s[10:11]
    v_add_u32 v7, 0x2000, v7
    global_load_dwordx2 v[26:27], v7, s[10:11]
    v_add_u32 v7, 0x2000, v7
    global_load_dwordx2 v[28:29], v7, s[10:11]
    v_add_u32 v7, 0x2000, v7
    global_load_dwordx2 v[30:31], v7, s[10:11]
    s_cmp_lt_u32 s2, 112
    s_cbranch_scc0 K1B_NOW1
    s_and_b32 s33, s2, 3
    s_lshr_b32 s34, s2, 2
    s_lshl_b32 s29, s33, 7
    s_lshl_b32 s30, s28, 5
    s_add_u32 s29, s29, s30
    v_lshlrev_b32 v6, 3, v3
    v_add_u32 v6, s29, v6
    s_movk_i32 s35, 3584
    v_mul_lo_u32 v7, v6, s35
    s_lshl_b32 s30, s34, 7
    v_lshlrev_b32 v6, 3, v4
    v_add_u32 v7, v7, v6
    v_add_u32 v7, s30, v7
    global_load_dwordx2 v[32:33], v7, s[12:13]
    v_add_u32 v7, 0xe00, v7
    global_load_dwordx2 v[34:35], v7, s[12:13]
    v_add_u32 v7, 0xe00, v7
    global_load_dwordx2 v[36:37], v7, s[12:13]
    v_add_u32 v7, 0xe00, v7
    global_load_dwordx2 v[38:39], v7, s[12:13]
    v_add_u32 v7, 0xe00, v7
    global_load_dwordx2 v[40:41], v7, s[12:13]
    v_add_u32 v7, 0xe00, v7
    global_load_dwordx2 v[42:43], v7, s[12:13]
    v_add_u32 v7, 0xe00, v7
    global_load_dwordx2 v[44:45], v7, s[12:13]
    v_add_u32 v7, 0xe00, v7
    global_load_dwordx2 v[46:47], v7, s[12:13]
K1B_NOW1:
    s_lshl_b32 s29, s24, 3
    s_add_u32 s29, s29, s22
    s_lshl_b32 s29, s29, 20
    s_lshl_b32 s30, s25, 16
    s_add_u32 s29, s29, s30
    s_lshl_b32 s30, s28, 14
    s_add_u32 s29, s29, s30
    s_add_u32 s29, s29, 0xc0000
    s_add_u32 s6, s6, s29
    s_addc_u32 s7, s7, 0
    s_add_u32 s8, s8, s29
    s_addc_u32 s9, s9, 0
    v_lshlrev_b32 v6, 8, v4
    v_lshlrev_b32 v7, 4, v3
    v_add_u32 v6, v6, v7
    global_load_dwordx4 v[64:67], v6, s[6:7] offset:0
    global_load_dwordx4 v[68:71], v6, s[6:7] offset:64
    global_load_dwordx4 v[72:75], v6, s[6:7] offset:128
    global_load_dwordx4 v[76:79], v6, s[6:7] offset:192
    v_add_u32 v6, 0x1000, v6
    global_load_dwordx4 v[80:83], v6, s[6:7] offset:0
    global_load_dwordx4 v[84:87], v6, s[6:7] offset:64
    global_load_dwordx4 v[88:91], v6, s[6:7] offset:128
    global_load_dwordx4 v[92:95], v6, s[6:7] offset:192
    v_add_u32 v6, 0x1000, v6
    global_load_dwordx4 v[96:99], v6, s[6:7] offset:0
    global_load_dwordx4 v[100:103], v6, s[6:7] offset:64
    global_load_dwordx4 v[104:107], v6, s[6:7] offset:128
    global_load_dwordx4 v[108:111], v6, s[6:7] offset:192
    v_add_u32 v6, 0x1000, v6
    global_load_dwordx4 v[112:115], v6, s[6:7] offset:0
    global_load_dwordx4 v[116:119], v6, s[6:7] offset:64
    global_load_dwordx4 v[120:123], v6, s[6:7] offset:128
    global_load_dwordx4 v[124:127], v6, s[6:7] offset:192
    v_lshlrev_b32 v6, 10, v3
    v_lshlrev_b32 v7, 4, v4
    v_add_u32 v6, v6, v7
    global_load_dwordx4 v[128:131], v6, s[8:9] offset:0
    global_load_dwordx4 v[132:135], v6, s[8:9] offset:256
    global_load_dwordx4 v[136:139], v6, s[8:9] offset:512
    global_load_dwordx4 v[140:143], v6, s[8:9] offset:768
    v_add_u32 v6, 0x1000, v6
    global_load_dwordx4 v[144:147], v6, s[8:9] offset:0
    global_load_dwordx4 v[148:151], v6, s[8:9] offset:256
    global_load_dwordx4 v[152:155], v6, s[8:9] offset:512
    global_load_dwordx4 v[156:159], v6, s[8:9] offset:768
    v_add_u32 v6, 0x1000, v6
    global_load_dwordx4 v[160:163], v6, s[8:9] offset:0
    global_load_dwordx4 v[164:167], v6, s[8:9] offset:256
    global_load_dwordx4 v[168:171], v6, s[8:9] offset:512
    global_load_dwordx4 v[172:175], v6, s[8:9] offset:768
    v_add_u32 v6, 0x1000, v6
    global_load_dwordx4 v[176:179], v6, s[8:9] offset:0
    global_load_dwordx4 v[180:183], v6, s[8:9] offset:256
    global_load_dwordx4 v[184:187], v6, s[8:9] offset:512
    global_load_dwordx4 v[188:191], v6, s[8:9] offset:768
    s_branch K1B_B3
    s_cmp_lt_u32 s2, 112
    s_cbranch_scc0 K1B_WX2
    s_waitcnt vmcnt(16)
    s_branch K1B_WX3
K1B_WX2:
    s_waitcnt vmcnt(8)
K1B_WX3:
    v_lshlrev_b32 v192, 16, v8
    v_and_b32 v193, 0xffff0000, v8
    v_lshlrev_b32 v194, 16, v9
    v_and_b32 v195, 0xffff0000, v9
    v_lshlrev_b32 v196, 16, v10
    v_and_b32 v197, 0xffff0000, v10
    v_lshlrev_b32 v198, 16, v11
    v_and_b32 v199, 0xffff0000, v11
    v_lshlrev_b32 v200, 16, v12
    v_and_b32 v201, 0xffff0000, v12
    v_lshlrev_b32 v202, 16, v13
    v_and_b32 v203, 0xffff0000, v13
    v_lshlrev_b32 v204, 16, v14
    v_and_b32 v205, 0xffff0000, v14
    v_lshlrev_b32 v206, 16, v15
    v_and_b32 v207, 0xffff0000, v15
    v_add_f32 v208, v192, v193
    v_add_f32 v208, v208, v194
    v_add_f32 v208, v208, v195
    v_add_f32 v208, v208, v196
    v_add_f32 v208, v208, v197
    v_add_f32 v208, v208, v198
    v_add_f32 v208, v208, v199
    v_add_f32 v208, v208, v200
    v_add_f32 v208, v208, v201
    v_add_f32 v208, v208, v202
    v_add_f32 v208, v208, v203
    v_add_f32 v208, v208, v204
    v_add_f32 v208, v208, v205
    v_add_f32 v208, v208, v206
    v_add_f32 v208, v208, v207
    ds_swizzle_b32 v209, v208 offset:1055
    s_waitcnt lgkmcnt(0)
    v_add_f32 v208, v208, v209
    ds_swizzle_b32 v209, v208 offset:2079
    s_waitcnt lgkmcnt(0)
    v_add_f32 v208, v208, v209
    ds_swizzle_b32 v209, v208 offset:4127
    s_waitcnt lgkmcnt(0)
    v_add_f32 v208, v208, v209
    ds_swizzle_b32 v209, v208 offset:8223
    s_waitcnt lgkmcnt(0)
    v_add_f32 v208, v208, v209
    ds_swizzle_b32 v209, v208 offset:16415
    s_waitcnt lgkmcnt(0)
    v_add_f32 v208, v208, v209
    v_mul_f32 v208, 0x3b000000, v208
    v_sub_f32 v192, v192, v208
    v_sub_f32 v193, v193, v208
    v_sub_f32 v194, v194, v208
    v_sub_f32 v195, v195, v208
    v_sub_f32 v196, v196, v208
    v_sub_f32 v197, v197, v208
    v_sub_f32 v198, v198, v208
    v_sub_f32 v199, v199, v208
    v_sub_f32 v200, v200, v208
    v_sub_f32 v201, v201, v208
    v_sub_f32 v202, v202, v208
    v_sub_f32 v203, v203, v208
    v_sub_f32 v204, v204, v208
    v_sub_f32 v205, v205, v208
    v_sub_f32 v206, v206, v208
    v_sub_f32 v207, v207, v208
    v_mul_f32 v210, v192, v192
    v_fmac_f32 v210, v193, v193
    v_fmac_f32 v210, v194, v194
    v_fmac_f32 v210, v195, v195
    v_fmac_f32 v210, v196, v196
    v_fmac_f32 v210, v197, v197
    v_fmac_f32 v210, v198, v198
    v_fmac_f32 v210, v199, v199
    v_fmac_f32 v210, v200, v200
    v_fmac_f32 v210, v201, v201
    v_fmac_f32 v210, v202, v202
    v_fmac_f32 v210, v203, v203
    v_fmac_f32 v210, v204, v204
    v_fmac_f32 v210, v205, v205
    v_fmac_f32 v210, v206, v206
    v_fmac_f32 v210, v207, v207
    ds_swizzle_b32 v209, v210 offset:1055
    s_waitcnt lgkmcnt(0)
    v_add_f32 v210, v210, v209
    ds_swizzle_b32 v209, v210 offset:2079
    s_waitcnt lgkmcnt(0)
    v_add_f32 v210, v210, v209
    ds_swizzle_b32 v209, v210 offset:4127
    s_waitcnt lgkmcnt(0)
    v_add_f32 v210, v210, v209
    ds_swizzle_b32 v209, v210 offset:8223
    s_waitcnt lgkmcnt(0)
    v_add_f32 v210, v210, v209
    ds_swizzle_b32 v209, v210 offset:16415
    s_waitcnt lgkmcnt(0)
    v_add_f32 v210, v210, v209
    v_mov_b32 v211, 0x3727c5ac
    v_fmac_f32 v211, 0x3b000000, v210
    v_rsq_f32 v211, v211
    s_nop 0
    v_mul_f32 v192, v192, v211
    v_mul_f32 v193, v193, v211
    v_mul_f32 v194, v194, v211
    v_mul_f32 v195, v195, v211
    v_mul_f32 v196, v196, v211
    v_mul_f32 v197, v197, v211
    v_mul_f32 v198, v198, v211
    v_mul_f32 v199, v199, v211
    v_mul_f32 v200, v200, v211
    v_mul_f32 v201, v201, v211
    v_mul_f32 v202, v202, v211
    v_mul_f32 v203, v203, v211
    v_mul_f32 v204, v204, v211
    v_mul_f32 v205, v205, v211
    v_mul_f32 v206, v206, v211
    v_mul_f32 v207, v207, v211
    v_cvt_pk_bf16_f32 v8, v192, v193
    v_cvt_pk_bf16_f32 v9, v194, v195
    v_cvt_pk_bf16_f32 v10, v196, v197
    v_cvt_pk_bf16_f32 v11, v198, v199
    v_cvt_pk_bf16_f32 v12, v200, v201
    v_cvt_pk_bf16_f32 v13, v202, v203
    v_cvt_pk_bf16_f32 v14, v204, v205
    v_cvt_pk_bf16_f32 v15, v206, v207
    v_lshrrev_b32 v5, 5, v0
    v_mul_u32_u24 v5, 1040, v5
    v_and_b32 v6, 31, v0
    v_lshlrev_b32 v6, 5, v6
    v_add_u32 v5, v5, v6
    ds_write_b128 v5, v[8:11] offset:0
    ds_write_b128 v5, v[12:15] offset:16
    s_waitcnt lgkmcnt(0)
    s_barrier
    v_and_b32 v5, 7, v4
    v_mul_u32_u24 v5, 1040, v5
    v_lshlrev_b32 v6, 4, v3
    v_add_u32 v5, v5, v6
    s_lshl_b32 s29, s28, 6
    v_add_u32 v5, s29, v5
    s_lshl_b32 s30, s27, 8
    v_add_u32 v6, s30, v5
    ds_read_b128 v[192:195], v6 offset:0
    s_cmp_lt_u32 s2, 112
    s_cbranch_scc0 K1B_WQ2
    s_waitcnt vmcnt(8) lgkmcnt(0)
    s_branch K1B_WQ3
K1B_WQ2:
    s_waitcnt vmcnt(0) lgkmcnt(0)
K1B_WQ3:
    v_perm_b32 v196, v18, v16, s20
    v_perm_b32 v197, v22, v20, s20
    v_perm_b32 v198, v26, v24, s20
    v_perm_b32 v199, v30, v28, s20
    s_nop 1
    v_mfma_f32_16x16x32_bf16 v[200:203], v[192:195], v[196:199], 0
    s_nop 3
    v_perm_b32 v196, v18, v16, s21
    v_perm_b32 v197, v22, v20, s21
    v_perm_b32 v198, v26, v24, s21
    v_perm_b32 v199, v30, v28, s21
    s_nop 1
    v_mfma_f32_16x16x32_bf16 v[204:207], v[192:195], v[196:199], 0
    s_nop 3
    v_perm_b32 v196, v19, v17, s20
    v_perm_b32 v197, v23, v21, s20
    v_perm_b32 v198, v27, v25, s20
    v_perm_b32 v199, v31, v29, s20
    s_nop 1
    v_mfma_f32_16x16x32_bf16 v[208:211], v[192:195], v[196:199], 0
    s_nop 3
    v_perm_b32 v196, v19, v17, s21
    v_perm_b32 v197, v23, v21, s21
    v_perm_b32 v198, v27, v25, s21
    v_perm_b32 v199, v31, v29, s21
    s_nop 1
    v_mfma_f32_16x16x32_bf16 v[212:215], v[192:195], v[196:199], 0
    s_nop 3
    s_nop 7
    v_lshlrev_b32 v7, 10, v3
    v_lshlrev_b32 v6, 4, v4
    v_add_u32 v7, v7, v6
    s_lshl_b32 s29, s28, 11
    v_add_u32 v7, s29, v7
    v_cmp_gt_u32 vcc, 32, v1
    s_and_saveexec_b64 s[36:37], vcc
    ds_write_b32 v7, v200 offset:8448
    ds_write_b32 v7, v204 offset:8452
    ds_write_b32 v7, v208 offset:8456
    ds_write_b32 v7, v212 offset:8460
    ds_write_b32 v7, v201 offset:8704
    ds_write_b32 v7, v205 offset:8708
    ds_write_b32 v7, v209 offset:8712
    ds_write_b32 v7, v213 offset:8716
    ds_write_b32 v7, v202 offset:8960
    ds_write_b32 v7, v206 offset:8964
    ds_write_b32 v7, v210 offset:8968
    ds_write_b32 v7, v214 offset:8972
    ds_write_b32 v7, v203 offset:9216
    ds_write_b32 v7, v207 offset:9220
    ds_write_b32 v7, v211 offset:9224
    ds_write_b32 v7, v215 offset:9228
    s_mov_b64 exec, s[36:37]
    s_cmp_lt_u32 s2, 112
    s_cbranch_scc0 K1B_NOH
    s_lshl_b32 s30, s33, 8
    v_add_u32 v6, s30, v5
    ds_read_b128 v[192:195], v6 offset:0
    s_waitcnt vmcnt(0) lgkmcnt(0)
    v_perm_b32 v196, v34, v32, s20
    v_perm_b32 v197, v38, v36, s20
    v_perm_b32 v198, v42, v40, s20
    v_perm_b32 v199, v46, v44, s20
    s_nop 1
    v_mfma_f32_16x16x32_bf16 v[200:203], v[192:195], v[196:199], 0
    s_nop 3
    v_perm_b32 v196, v34, v32, s21
    v_perm_b32 v197, v38, v36, s21
    v_perm_b32 v198, v42, v40, s21
    v_perm_b32 v199, v46, v44, s21
    s_nop 1
    v_mfma_f32_16x16x32_bf16 v[204:207], v[192:195], v[196:199], 0
    s_nop 3
    v_perm_b32 v196, v35, v33, s20
    v_perm_b32 v197, v39, v37, s20
    v_perm_b32 v198, v43, v41, s20
    v_perm_b32 v199, v47, v45, s20
    s_nop 1
    v_mfma_f32_16x16x32_bf16 v[208:211], v[192:195], v[196:199], 0
    s_nop 3
    v_perm_b32 v196, v35, v33, s21
    v_perm_b32 v197, v39, v37, s21
    v_perm_b32 v198, v43, v41, s21
    v_perm_b32 v199, v47, v45, s21
    s_nop 1
    v_mfma_f32_16x16x32_bf16 v[212:215], v[192:195], v[196:199], 0
    s_nop 3
    s_nop 7
    s_and_saveexec_b64 s[36:37], vcc
    ds_write_b32 v7, v200 offset:16640
    ds_write_b32 v7, v204 offset:16644
    ds_write_b32 v7, v208 offset:16648
    ds_write_b32 v7, v212 offset:16652
    ds_write_b32 v7, v201 offset:16896
    ds_write_b32 v7, v205 offset:16900
    ds_write_b32 v7, v209 offset:16904
    ds_write_b32 v7, v213 offset:16908
    ds_write_b32 v7, v202 offset:17152
    ds_write_b32 v7, v206 offset:17156
    ds_write_b32 v7, v210 offset:17160
    ds_write_b32 v7, v214 offset:17164
    ds_write_b32 v7, v203 offset:17408
    ds_write_b32 v7, v207 offset:17412
    ds_write_b32 v7, v211 offset:17416
    ds_write_b32 v7, v215 offset:17420
    s_mov_b64 exec, s[36:37]
K1B_NOH:
    s_waitcnt lgkmcnt(0)
    s_barrier
K1B_B3:
    s_barrier
    v_and_b32 v5, 3, v4
    v_mul_u32_u24 v5, 272, v5
    v_lshlrev_b32 v6, 4, v3
    v_add_u32 v5, v5, v6
    ds_read_b128 v[8:11], v5 offset:24832
    ds_read_b128 v[12:15], v5 offset:24896
    ds_read_b128 v[16:19], v5 offset:24960
    ds_read_b128 v[20:23], v5 offset:25024
    s_waitcnt vmcnt(16) lgkmcnt(0)
    v_mfma_f32_16x16x32_bf16 v[24:27], v[64:67], v[8:11], 0
    v_mfma_f32_16x16x32_bf16 v[24:27], v[68:71], v[12:15], v[24:27]
    v_mfma_f32_16x16x32_bf16 v[24:27], v[72:75], v[16:19], v[24:27]
    v_mfma_f32_16x16x32_bf16 v[24:27], v[76:79], v[20:23], v[24:27]
    v_mfma_f32_16x16x32_bf16 v[28:31], v[80:83], v[8:11], 0
    v_mfma_f32_16x16x32_bf16 v[28:31], v[84:87], v[12:15], v[28:31]
    v_mfma_f32_16x16x32_bf16 v[28:31], v[88:91], v[16:19], v[28:31]
    v_mfma_f32_16x16x32_bf16 v[28:31], v[92:95], v[20:23], v[28:31]
    v_mfma_f32_16x16x32_bf16 v[32:35], v[96:99], v[8:11], 0
    v_mfma_f32_16x16x32_bf16 v[32:35], v[100:103], v[12:15], v[32:35]
    v_mfma_f32_16x16x32_bf16 v[32:35], v[104:107], v[16:19], v[32:35]
    v_mfma_f32_16x16x32_bf16 v[32:35], v[108:111], v[20:23], v[32:35]
    v_mfma_f32_16x16x32_bf16 v[36:39], v[112:115], v[8:11], 0
    v_mfma_f32_16x16x32_bf16 v[36:39], v[116:119], v[12:15], v[36:39]
    v_mfma_f32_16x16x32_bf16 v[36:39], v[120:123], v[16:19], v[36:39]
    v_mfma_f32_16x16x32_bf16 v[36:39], v[124:127], v[20:23], v[36:39]
    s_nop 9
    v_max_f32 v40, v24, v25
    v_max_f32 v40, v40, v26
    v_max_f32 v40, v40, v27
    v_max_f32 v40, v40, v28
    v_max_f32 v40, v40, v29
    v_max_f32 v40, v40, v30
    v_max_f32 v40, v40, v31
    v_max_f32 v40, v40, v32
    v_max_f32 v40, v40, v33
    v_max_f32 v40, v40, v34
    v_max_f32 v40, v40, v35
    v_max_f32 v40, v40, v36
    v_max_f32 v40, v40, v37
    v_max_f32 v40, v40, v38
    v_max_f32 v40, v40, v39
    v_lshlrev_b32 v41, 2, v1
    v_xor_b32 v42, 64, v41
    v_xor_b32 v43, 128, v41
    ds_bpermute_b32 v44, v42, v40
    s_waitcnt lgkmcnt(0)
    v_max_f32 v40, v40, v44
    ds_bpermute_b32 v44, v43, v40
    s_waitcnt lgkmcnt(0)
    v_max_f32 v40, v40, v44
    v_mov_b32 v45, 0x3e0293ee
    v_mul_f32 v46, v40, v45
    v_fma_f32 v24, v24, v45, -v46
    v_fma_f32 v25, v25, v45, -v46
    v_fma_f32 v26, v26, v45, -v46
    v_fma_f32 v27, v27, v45, -v46
    v_fma_f32 v28, v28, v45, -v46
    v_fma_f32 v29, v29, v45, -v46
    v_fma_f32 v30, v30, v45, -v46
    v_fma_f32 v31, v31, v45, -v46
    v_fma_f32 v32, v32, v45, -v46
    v_fma_f32 v33, v33, v45, -v46
    v_fma_f32 v34, v34, v45, -v46
    v_fma_f32 v35, v35, v45, -v46
    v_fma_f32 v36, v36, v45, -v46
    v_fma_f32 v37, v37, v45, -v46
    v_fma_f32 v38, v38, v45, -v46
    v_fma_f32 v39, v39, v45, -v46
    v_exp_f32 v24, v24
    v_exp_f32 v25, v25
    v_exp_f32 v26, v26
    v_exp_f32 v27, v27
    v_exp_f32 v28, v28
    v_exp_f32 v29, v29
    v_exp_f32 v30, v30
    v_exp_f32 v31, v31
    v_exp_f32 v32, v32
    v_exp_f32 v33, v33
    v_exp_f32 v34, v34
    v_exp_f32 v35, v35
    v_exp_f32 v36, v36
    v_exp_f32 v37, v37
    v_exp_f32 v38, v38
    v_exp_f32 v39, v39
    s_nop 0
    v_add_f32 v47, v24, v25
    v_add_f32 v47, v47, v26
    v_add_f32 v47, v47, v27
    v_add_f32 v47, v47, v28
    v_add_f32 v47, v47, v29
    v_add_f32 v47, v47, v30
    v_add_f32 v47, v47, v31
    v_add_f32 v47, v47, v32
    v_add_f32 v47, v47, v33
    v_add_f32 v47, v47, v34
    v_add_f32 v47, v47, v35
    v_add_f32 v47, v47, v36
    v_add_f32 v47, v47, v37
    v_add_f32 v47, v47, v38
    v_add_f32 v47, v47, v39
    ds_bpermute_b32 v44, v42, v47
    s_waitcnt lgkmcnt(0)
    v_add_f32 v47, v47, v44
    ds_bpermute_b32 v44, v43, v47
    s_waitcnt lgkmcnt(0)
    v_add_f32 v47, v47, v44
    v_cvt_pk_bf16_f32 v48, v24, v25
    v_cvt_pk_bf16_f32 v49, v26, v27
    v_cvt_pk_bf16_f32 v50, v28, v29
    v_cvt_pk_bf16_f32 v51, v30, v31
    v_cvt_pk_bf16_f32 v52, v32, v33
    v_cvt_pk_bf16_f32 v53, v34, v35
    v_cvt_pk_bf16_f32 v54, v36, v37
    v_cvt_pk_bf16_f32 v55, v38, v39
    s_waitcnt vmcnt(0)
    v_perm_b32 v56, v132, v128, s20
    v_perm_b32 v57, v140, v136, s20
    v_perm_b32 v58, v148, v144, s20
    v_perm_b32 v59, v156, v152, s20
    s_nop 1
    v_mfma_f32_16x16x32_bf16 v[192:195], v[48:51], v[56:59], 0
    s_nop 3
    v_perm_b32 v56, v132, v128, s21
    v_perm_b32 v57, v140, v136, s21
    v_perm_b32 v58, v148, v144, s21
    v_perm_b32 v59, v156, v152, s21
    s_nop 1
    v_mfma_f32_16x16x32_bf16 v[196:199], v[48:51], v[56:59], 0
    s_nop 3
    v_perm_b32 v56, v133, v129, s20
    v_perm_b32 v57, v141, v137, s20
    v_perm_b32 v58, v149, v145, s20
    v_perm_b32 v59, v157, v153, s20
    s_nop 1
    v_mfma_f32_16x16x32_bf16 v[200:203], v[48:51], v[56:59], 0
    s_nop 3
    v_perm_b32 v56, v133, v129, s21
    v_perm_b32 v57, v141, v137, s21
    v_perm_b32 v58, v149, v145, s21
    v_perm_b32 v59, v157, v153, s21
    s_nop 1
    v_mfma_f32_16x16x32_bf16 v[204:207], v[48:51], v[56:59], 0
    s_nop 3
    v_perm_b32 v56, v134, v130, s20
    v_perm_b32 v57, v142, v138, s20
    v_perm_b32 v58, v150, v146, s20
    v_perm_b32 v59, v158, v154, s20
    s_nop 1
    v_mfma_f32_16x16x32_bf16 v[208:211], v[48:51], v[56:59], 0
    s_nop 3
    v_perm_b32 v56, v134, v130, s21
    v_perm_b32 v57, v142, v138, s21
    v_perm_b32 v58, v150, v146, s21
    v_perm_b32 v59, v158, v154, s21
    s_nop 1
    v_mfma_f32_16x16x32_bf16 v[212:215], v[48:51], v[56:59], 0
    s_nop 3
    v_perm_b32 v56, v135, v131, s20
    v_perm_b32 v57, v143, v139, s20
    v_perm_b32 v58, v151, v147, s20
    v_perm_b32 v59, v159, v155, s20
    s_nop 1
    v_mfma_f32_16x16x32_bf16 v[216:219], v[48:51], v[56:59], 0
    s_nop 3
    v_perm_b32 v56, v135, v131, s21
    v_perm_b32 v57, v143, v139, s21
    v_perm_b32 v58, v151, v147, s21
    v_perm_b32 v59, v159, v155, s21
    s_nop 1
    v_mfma_f32_16x16x32_bf16 v[220:223], v[48:51], v[56:59], 0
    s_nop 3
    v_perm_b32 v56, v164, v160, s20
    v_perm_b32 v57, v172, v168, s20
    v_perm_b32 v58, v180, v176, s20
    v_perm_b32 v59, v188, v184, s20
    s_nop 1
    v_mfma_f32_16x16x32_bf16 v[192:195], v[52:55], v[56:59], v[192:195]
    s_nop 3
    v_perm_b32 v56, v164, v160, s21
    v_perm_b32 v57, v172, v168, s21
    v_perm_b32 v58, v180, v176, s21
    v_perm_b32 v59, v188, v184, s21
    s_nop 1
    v_mfma_f32_16x16x32_bf16 v[196:199], v[52:55], v[56:59], v[196:199]
    s_nop 3
    v_perm_b32 v56, v165, v161, s20
    v_perm_b32 v57, v173, v169, s20
    v_perm_b32 v58, v181, v177, s20
    v_perm_b32 v59, v189, v185, s20
    s_nop 1
    v_mfma_f32_16x16x32_bf16 v[200:203], v[52:55], v[56:59], v[200:203]
    s_nop 3
    v_perm_b32 v56, v165, v161, s21
    v_perm_b32 v57, v173, v169, s21
    v_perm_b32 v58, v181, v177, s21
    v_perm_b32 v59, v189, v185, s21
    s_nop 1
    v_mfma_f32_16x16x32_bf16 v[204:207], v[52:55], v[56:59], v[204:207]
    s_nop 3
    v_perm_b32 v56, v166, v162, s20
    v_perm_b32 v57, v174, v170, s20
    v_perm_b32 v58, v182, v178, s20
    v_perm_b32 v59, v190, v186, s20
    s_nop 1
    v_mfma_f32_16x16x32_bf16 v[208:211], v[52:55], v[56:59], v[208:211]
    s_nop 3
    v_perm_b32 v56, v166, v162, s21
    v_perm_b32 v57, v174, v170, s21
    v_perm_b32 v58, v182, v178, s21
    v_perm_b32 v59, v190, v186, s21
    s_nop 1
    v_mfma_f32_16x16x32_bf16 v[212:215], v[52:55], v[56:59], v[212:215]
    s_nop 3
    v_perm_b32 v56, v167, v163, s20
    v_perm_b32 v57, v175, v171, s20
    v_perm_b32 v58, v183, v179, s20
    v_perm_b32 v59, v191, v187, s20
    s_nop 1
    v_mfma_f32_16x16x32_bf16 v[216:219], v[52:55], v[56:59], v[216:219]
    s_nop 3
    v_perm_b32 v56, v167, v163, s21
    v_perm_b32 v57, v175, v171, s21
    v_perm_b32 v58, v183, v179, s21
    v_perm_b32 v59, v191, v187, s21
    s_nop 1
    v_mfma_f32_16x16x32_bf16 v[220:223], v[52:55], v[56:59], v[220:223]
    s_nop 3
    s_nop 9
    v_lshlrev_b32 v5, 5, v1
    s_lshl_b32 s29, s28, 11
    v_add_u32 v5, s29, v5
    v_cmp_gt_u32 vcc, 16, v1
    s_and_saveexec_b64 s[36:37], vcc
    ds_write_b32 v5, v192 offset:25984
    ds_write_b32 v5, v196 offset:25988
    ds_write_b32 v5, v200 offset:25992
    ds_write_b32 v5, v204 offset:25996
    ds_write_b32 v5, v208 offset:26000
    ds_write_b32 v5, v212 offset:26004
    ds_write_b32 v5, v216 offset:26008
    ds_write_b32 v5, v220 offset:26012
    ds_write_b32 v5, v193 offset:26496
    ds_write_b32 v5, v197 offset:26500
    ds_write_b32 v5, v201 offset:26504
    ds_write_b32 v5, v205 offset:26508
    ds_write_b32 v5, v209 offset:26512
    ds_write_b32 v5, v213 offset:26516
    ds_write_b32 v5, v217 offset:26520
    ds_write_b32 v5, v221 offset:26524
    ds_write_b32 v5, v194 offset:27008
    ds_write_b32 v5, v198 offset:27012
    ds_write_b32 v5, v202 offset:27016
    ds_write_b32 v5, v206 offset:27020
    ds_write_b32 v5, v210 offset:27024
    ds_write_b32 v5, v214 offset:27028
    ds_write_b32 v5, v218 offset:27032
    ds_write_b32 v5, v222 offset:27036
    ds_write_b32 v5, v195 offset:27520
    ds_write_b32 v5, v199 offset:27524
    ds_write_b32 v5, v203 offset:27528
    ds_write_b32 v5, v207 offset:27532
    ds_write_b32 v5, v211 offset:27536
    ds_write_b32 v5, v215 offset:27540
    ds_write_b32 v5, v219 offset:27544
    ds_write_b32 v5, v223 offset:27548
    v_cmp_gt_u32 vcc, 4, v1
    s_and_b64 exec, exec, vcc
    v_lshlrev_b32 v5, 3, v1
    s_lshl_b32 s29, s28, 5
    v_add_u32 v5, s29, v5
    v_mov_b32 v49, v47
    v_mov_b32 v48, v40
    ds_write_b64 v5, v[48:49] offset:34176
    s_mov_b64 exec, s[36:37]
    s_waitcnt lgkmcnt(0)
    s_barrier
    s_cmp_ge_u32 s28, 2
    s_cbranch_scc1 K1B_END
    v_lshrrev_b32 v5, 5, v0
    v_lshlrev_b32 v6, 3, v5
    ds_read_b64 v[8:9], v6 offset:34176
    ds_read_b64 v[10:11], v6 offset:34208
    ds_read_b64 v[12:13], v6 offset:34240
    ds_read_b64 v[14:15], v6 offset:34272
    v_lshlrev_b32 v7, 9, v5
    v_and_b32 v16, 31, v0
    v_lshlrev_b32 v16, 4, v16
    v_add_u32 v7, v7, v16
    ds_read_b128 v[20:23], v7 offset:25984
    ds_read_b128 v[24:27], v7 offset:28032
    ds_read_b128 v[28:31], v7 offset:30080
    ds_read_b128 v[32:35], v7 offset:32128
    s_waitcnt lgkmcnt(0)
    v_max_f32 v17, v8, v10
    v_max3_f32 v17, v17, v12, v14
    v_mov_b32 v45, 0x3e0293ee
    v_sub_f32 v36, v8, v17
    v_mul_f32 v36, v36, v45
    v_sub_f32 v37, v10, v17
    v_mul_f32 v37, v37, v45
    v_sub_f32 v38, v12, v17
    v_mul_f32 v38, v38, v45
    v_sub_f32 v39, v14, v17
    v_mul_f32 v39, v39, v45
    v_exp_f32 v36, v36
    v_exp_f32 v37, v37
    v_exp_f32 v38, v38
    v_exp_f32 v39, v39
    s_nop 0
    v_mul_f32 v19, v9, v36
    v_fmac_f32 v19, v11, v37
    v_fmac_f32 v19, v13, v38
    v_fmac_f32 v19, v15, v39
    v_mul_f32 v40, v20, v36
    v_fmac_f32 v40, v24, v37
    v_fmac_f32 v40, v28, v38
    v_fmac_f32 v40, v32, v39
    v_mul_f32 v41, v21, v36
    v_fmac_f32 v41, v25, v37
    v_fmac_f32 v41, v29, v38
    v_fmac_f32 v41, v33, v39
    v_mul_f32 v42, v22, v36
    v_fmac_f32 v42, v26, v37
    v_fmac_f32 v42, v30, v38
    v_fmac_f32 v42, v34, v39
    v_mul_f32 v43, v23, v36
    v_fmac_f32 v43, v27, v37
    v_fmac_f32 v43, v31, v38
    v_fmac_f32 v43, v35, v39
    v_mov_b32 v18, v17
    s_lshl_b32 s29, s24, 5
    s_lshl_b32 s30, s22, 2
    s_add_u32 s29, s29, s30
    s_lshl_b32 s29, s29, 2
    s_add_u32 s29, s29, s25
    v_lshlrev_b32 v6, 2, v5
    v_add_u32 v6, s29, v6
    v_lshlrev_b32 v7, 9, v6
    v_add_u32 v7, v7, v16
    v_add_u32 v7, 0x100000, v7
    global_store_dwordx4 v7, v[40:43], s[18:19]
    v_lshlrev_b32 v7, 3, v6
    v_add_u32 v7, 0x180000, v7
    v_and_b32 v16, 31, v0
    v_cmp_eq_u32 vcc, 0, v16
    s_and_saveexec_b64 s[36:37], vcc
    global_store_dwordx2 v7, v[18:19], s[18:19]
    s_endpgm
K1B_HELPER:
    s_branch K1B_POLLED
    s_lshl_b32 s29, s2, 6
    v_lshlrev_b32 v5, 2, v1
    v_add_u32 v5, s29, v5
    v_add_u32 v5, 0x190000, v5
    v_mov_b32 v6, 0
    v_cmp_gt_u32 vcc, 16, v1
    s_and_saveexec_b64 s[36:37], vcc
    global_store_dword v5, v6, s[18:19]
    s_mov_b64 exec, s[36:37]
    s_barrier
    s_barrier
    v_lshlrev_b32 v5, 5, v1
    ds_read_b128 v[8:11], v5 offset:8448
    ds_read_b128 v[12:15], v5 offset:8464
    ds_read_b128 v[16:19], v5 offset:10496
    ds_read_b128 v[20:23], v5 offset:10512
    ds_read_b128 v[24:27], v5 offset:12544
    ds_read_b128 v[28:31], v5 offset:12560
    ds_read_b128 v[32:35], v5 offset:14592
    ds_read_b128 v[36:39], v5 offset:14608
    s_waitcnt lgkmcnt(0)
    v_add_f32 v8, v8, v16
    v_add_f32 v24, v24, v32
    v_add_f32 v8, v8, v24
    v_add_f32 v9, v9, v17
    v_add_f32 v25, v25, v33
    v_add_f32 v9, v9, v25
    v_add_f32 v10, v10, v18
    v_add_f32 v26, v26, v34
    v_add_f32 v10, v10, v26
    v_add_f32 v11, v11, v19
    v_add_f32 v27, v27, v35
    v_add_f32 v11, v11, v27
    v_add_f32 v12, v12, v20
    v_add_f32 v28, v28, v36
    v_add_f32 v12, v12, v28
    v_add_f32 v13, v13, v21
    v_add_f32 v29, v29, v37
    v_add_f32 v13, v13, v29
    v_add_f32 v14, v14, v22
    v_add_f32 v30, v30, v38
    v_add_f32 v14, v14, v30
    v_add_f32 v15, v15, v23
    v_add_f32 v31, v31, v39
    v_add_f32 v15, v15, v31
    s_lshl_b32 s29, s22, 2
    s_add_u32 s29, s29, s27
    s_lshl_b32 s29, s29, 14
    s_lshl_b32 s30, s26, 8
    s_add_u32 s29, s29, s30
    v_lshrrev_b32 v6, 3, v1
    v_lshlrev_b32 v6, 11, v6
    v_and_b32 v7, 7, v1
    v_lshlrev_b32 v7, 5, v7
    v_add_u32 v6, v6, v7
    v_add_u32 v6, s29, v6
    global_store_dwordx4 v6, v[8:11], s[18:19]
    global_store_dwordx4 v6, v[12:15], s[18:19] offset:16
    s_cmp_lt_u32 s2, 112
    s_cbranch_scc0 K1B_H_NOH
    ds_read_b128 v[8:11], v5 offset:16640
    ds_read_b128 v[12:15], v5 offset:16656
    ds_read_b128 v[16:19], v5 offset:18688
    ds_read_b128 v[20:23], v5 offset:18704
    ds_read_b128 v[24:27], v5 offset:20736
    ds_read_b128 v[28:31], v5 offset:20752
    ds_read_b128 v[32:35], v5 offset:22784
    ds_read_b128 v[36:39], v5 offset:22800
    s_waitcnt lgkmcnt(0)
    v_add_f32 v8, v8, v16
    v_add_f32 v24, v24, v32
    v_add_f32 v8, v8, v24
    v_add_f32 v9, v9, v17
    v_add_f32 v25, v25, v33
    v_add_f32 v9, v9, v25
    v_add_f32 v10, v10, v18
    v_add_f32 v26, v26, v34
    v_add_f32 v10, v10, v26
    v_add_f32 v11, v11, v19
    v_add_f32 v27, v27, v35
    v_add_f32 v11, v11, v27
    v_add_f32 v12, v12, v20
    v_add_f32 v28, v28, v36
    v_add_f32 v12, v12, v28
    v_add_f32 v13, v13, v21
    v_add_f32 v29, v29, v37
    v_add_f32 v13, v13, v29
    v_add_f32 v14, v14, v22
    v_add_f32 v30, v30, v38
    v_add_f32 v14, v14, v30
    v_add_f32 v15, v15, v23
    v_add_f32 v31, v31, v39
    v_add_f32 v15, v15, v31
    s_and_b32 s33, s2, 3
    s_lshr_b32 s34, s2, 2
    s_mul_i32 s29, s33, 57344
    s_lshl_b32 s30, s34, 8
    s_add_u32 s29, s29, s30
    s_add_u32 s29, s29, 0x80000
    v_lshrrev_b32 v6, 3, v1
    v_mul_u32_u24 v6, 7168, v6
    v_add_u32 v6, v6, v7
    v_add_u32 v6, s29, v6
    global_store_dwordx4 v6, v[8:11], s[18:19]
    global_store_dwordx4 v6, v[12:15], s[18:19] offset:16
K1B_H_NOH:
    s_waitcnt vmcnt(0)
    s_lshl_b32 s29, s22, 5
    v_mov_b32 v5, s29
    v_mov_b32 v6, 1
    v_cmp_eq_u32 vcc, 0, v1
    s_and_saveexec_b64 s[36:37], vcc
    global_atomic_add v5, v6, s[16:17]
    s_mov_b64 exec, s[36:37]
    s_mov_b32 s38, 200000
K1B_POLL:
    global_load_dword v6, v5, s[16:17]
    s_waitcnt vmcnt(0)
    v_readfirstlane_b32 s39, v6
    s_cmp_ge_u32 s39, 32
    s_cbranch_scc1 K1B_POLLED
    s_sleep 2
    s_sub_u32 s38, s38, 1
    s_cmp_lg_u32 s38, 0
    s_cbranch_scc1 K1B_POLL
K1B_POLLED:
    s_lshl_b32 s29, s22, 16
    s_lshl_b32 s30, s24, 11
    s_add_u32 s29, s29, s30
    v_lshlrev_b32 v5, 5, v1
    v_add_u32 v5, s29, v5
    global_load_dwordx4 v[8:11], v5, s[18:19]
    global_load_dwordx4 v[12:15], v5, s[18:19] offset:16
    v_add_u32 v5, 0x4000, v5
    global_load_dwordx4 v[16:19], v5, s[18:19]
    global_load_dwordx4 v[20:23], v5, s[18:19] offset:16
    v_add_u32 v5, 0x4000, v5
    global_load_dwordx4 v[24:27], v5, s[18:19]
    global_load_dwordx4 v[28:31], v5, s[18:19] offset:16
    v_add_u32 v5, 0x4000, v5
    global_load_dwordx4 v[32:35], v5, s[18:19]
    global_load_dwordx4 v[36:39], v5, s[18:19] offset:16
    s_waitcnt vmcnt(0)
    v_add_f32 v8, v8, v16
    v_add_f32 v24, v24, v32
    v_add_f32 v8, v8, v24
    v_add_f32 v9, v9, v17
    v_add_f32 v25, v25, v33
    v_add_f32 v9, v9, v25
    v_add_f32 v10, v10, v18
    v_add_f32 v26, v26, v34
    v_add_f32 v10, v10, v26
    v_add_f32 v11, v11, v19
    v_add_f32 v27, v27, v35
    v_add_f32 v11, v11, v27
    v_add_f32 v12, v12, v20
    v_add_f32 v28, v28, v36
    v_add_f32 v12, v12, v28
    v_add_f32 v13, v13, v21
    v_add_f32 v29, v29, v37
    v_add_f32 v13, v13, v29
    v_add_f32 v14, v14, v22
    v_add_f32 v30, v30, v38
    v_add_f32 v14, v14, v30
    v_add_f32 v15, v15, v23
    v_add_f32 v31, v31, v39
    v_add_f32 v15, v15, v31
    v_cvt_pk_bf16_f32 v40, v8, v9
    v_cvt_pk_bf16_f32 v41, v10, v11
    v_cvt_pk_bf16_f32 v42, v12, v13
    v_cvt_pk_bf16_f32 v43, v14, v15
    v_mul_u32_u24 v5, 272, v3
    v_lshlrev_b32 v6, 4, v4
    v_add_u32 v5, v5, v6
    ds_write_b128 v5, v[40:43] offset:24832
    s_waitcnt lgkmcnt(0)
    s_barrier
    s_barrier
K1B_END:
    s_endpgm
.globl parallel_sum__sliding_block_cached__dense_activation_gelu__decode_kernel
.p2align 8
.type parallel_sum__sliding_block_cached__dense_activation_gelu__decode_kernel,@function
parallel_sum__sliding_block_cached__dense_activation_gelu__decode_kernel:
    s_cmp_ge_u32 s2, 256
    s_cbranch_scc1 K2_END
    s_load_dwordx2 s[4:5], s[0:1], 0
    s_load_dwordx2 s[6:7], s[0:1], 32
    s_load_dwordx4 s[8:11], s[0:1], 56
    s_load_dwordx4 s[12:15], s[0:1], 72
    s_load_dwordx4 s[16:19], s[0:1], 88
    s_mov_b32 s20, 0x05040100
    s_mov_b32 s21, 0x07060302
    s_lshr_b32 s22, s2, 3
    s_and_b32 s23, s2, 7
    v_and_b32 v1, 63, v0
    v_lshrrev_b32 v2, 6, v0
    v_lshrrev_b32 v3, 4, v1
    v_and_b32 v4, 15, v1
    v_readfirstlane_b32 s28, v2
    s_waitcnt lgkmcnt(0)
    s_lshl_b32 s29, s22, 7
    s_lshl_b32 s30, s28, 5
    s_add_u32 s29, s29, s30
    v_lshlrev_b32 v6, 3, v3
    v_add_u32 v6, s29, v6
    v_lshlrev_b32 v7, 10, v6
    s_lshl_b32 s30, s23, 7
    v_lshlrev_b32 v5, 3, v4
    v_add_u32 v7, v7, v5
    v_add_u32 v7, s30, v7
    global_load_dwordx2 v[16:17], v7, s[6:7] offset:0
    global_load_dwordx2 v[18:19], v7, s[6:7] offset:1024
    global_load_dwordx2 v[20:21], v7, s[6:7] offset:2048
    global_load_dwordx2 v[22:23], v7, s[6:7] offset:3072
    v_add_u32 v7, 0x1000, v7
    global_load_dwordx2 v[24:25], v7, s[6:7] offset:0
    global_load_dwordx2 v[26:27], v7, s[6:7] offset:1024
    global_load_dwordx2 v[28:29], v7, s[6:7] offset:2048
    global_load_dwordx2 v[30:31], v7, s[6:7] offset:3072
    s_mul_i32 s29, s22, 56
    s_lshl_b32 s31, s28, 5
    s_add_u32 s29, s29, s31
    v_lshlrev_b32 v6, 3, v3
    v_add_u32 v6, s29, v6
    v_add_u32 v7, 0, v6
    v_min_u32 v7, 1791, v7
    v_lshlrev_b32 v7, 10, v7
    v_add_u32 v7, v7, v5
    v_add_u32 v7, s30, v7
    global_load_dwordx2 v[32:33], v7, s[10:11]
    v_add_u32 v7, 1, v6
    v_min_u32 v7, 1791, v7
    v_lshlrev_b32 v7, 10, v7
    v_add_u32 v7, v7, v5
    v_add_u32 v7, s30, v7
    global_load_dwordx2 v[34:35], v7, s[10:11]
    v_add_u32 v7, 2, v6
    v_min_u32 v7, 1791, v7
    v_lshlrev_b32 v7, 10, v7
    v_add_u32 v7, v7, v5
    v_add_u32 v7, s30, v7
    global_load_dwordx2 v[36:37], v7, s[10:11]
    v_add_u32 v7, 3, v6
    v_min_u32 v7, 1791, v7
    v_lshlrev_b32 v7, 10, v7
    v_add_u32 v7, v7, v5
    v_add_u32 v7, s30, v7
    global_load_dwordx2 v[38:39], v7, s[10:11]
    v_add_u32 v7, 4, v6
    v_min_u32 v7, 1791, v7
    v_lshlrev_b32 v7, 10, v7
    v_add_u32 v7, v7, v5
    v_add_u32 v7, s30, v7
    global_load_dwordx2 v[40:41], v7, s[10:11]
    v_add_u32 v7, 5, v6
    v_min_u32 v7, 1791, v7
    v_lshlrev_b32 v7, 10, v7
    v_add_u32 v7, v7, v5
    v_add_u32 v7, s30, v7
    global_load_dwordx2 v[42:43], v7, s[10:11]
    v_add_u32 v7, 6, v6
    v_min_u32 v7, 1791, v7
    v_lshlrev_b32 v7, 10, v7
    v_add_u32 v7, v7, v5
    v_add_u32 v7, s30, v7
    global_load_dwordx2 v[44:45], v7, s[10:11]
    v_add_u32 v7, 7, v6
    v_min_u32 v7, 1791, v7
    v_lshlrev_b32 v7, 10, v7
    v_add_u32 v7, v7, v5
    v_add_u32 v7, s30, v7
    global_load_dwordx2 v[46:47], v7, s[10:11]
    v_lshrrev_b32 v8, 5, v0
    v_and_b32 v9, 31, v0
    v_lshlrev_b32 v10, 5, v8
    v_add_u32 v10, s22, v10
    v_lshlrev_b32 v10, 2, v10
    v_lshlrev_b32 v11, 9, v10
    v_lshlrev_b32 v12, 4, v9
    v_add_u32 v11, v11, v12
    v_add_u32 v11, 0x100000, v11
    global_load_dwordx4 v[48:51], v11, s[18:19] offset:0
    global_load_dwordx4 v[52:55], v11, s[18:19] offset:512
    global_load_dwordx4 v[56:59], v11, s[18:19] offset:1024
    global_load_dwordx4 v[60:63], v11, s[18:19] offset:1536
    v_lshlrev_b32 v12, 3, v10
    v_add_u32 v12, 0x180000, v12
    global_load_dwordx4 v[64:67], v12, s[18:19]
    global_load_dwordx4 v[68:71], v12, s[18:19] offset:16
    s_mul_i32 s29, s22, 224
    s_add_u32 s29, s29, 0x80000
    v_mul_u32_u24 v13, 7168, v8
    v_min_u32 v14, 27, v9
    v_lshlrev_b32 v14, 3, v14
    v_add_u32 v13, v13, v14
    v_add_u32 v13, s29, v13
    global_load_dwordx2 v[72:73], v13, s[18:19]
    v_add_u32 v13, 0xe000, v13
    global_load_dwordx2 v[74:75], v13, s[18:19]
    v_add_u32 v13, 0xe000, v13
    global_load_dwordx2 v[76:77], v13, s[18:19]
    v_add_u32 v13, 0xe000, v13
    global_load_dwordx2 v[78:79], v13, s[18:19]
    s_mul_i32 s29, s22, 112
    v_lshrrev_b32 v14, 1, v14
    v_add_u32 v14, s29, v14
    global_load_dword v80, v14, s[8:9]
    s_waitcnt vmcnt(5)
    v_max_f32 v84, v64, v66
    v_max3_f32 v84, v84, v68, v70
    v_mov_b32 v85, 0x3e0293ee
    v_sub_f32 v86, v64, v84
    v_mul_f32 v86, v86, v85
    v_sub_f32 v87, v66, v84
    v_mul_f32 v87, v87, v85
    v_sub_f32 v88, v68, v84
    v_mul_f32 v88, v88, v85
    v_sub_f32 v89, v70, v84
    v_mul_f32 v89, v89, v85
    v_exp_f32 v86, v86
    v_exp_f32 v87, v87
    v_exp_f32 v88, v88
    v_exp_f32 v89, v89
    s_nop 0
    v_mul_f32 v90, v65, v86
    v_fmac_f32 v90, v67, v87
    v_fmac_f32 v90, v69, v88
    v_fmac_f32 v90, v71, v89
    v_rcp_f32 v90, v90
    v_mul_f32 v92, v48, v86
    v_fmac_f32 v92, v52, v87
    v_fmac_f32 v92, v56, v88
    v_fmac_f32 v92, v60, v89
    v_mul_f32 v93, v49, v86
    v_fmac_f32 v93, v53, v87
    v_fmac_f32 v93, v57, v88
    v_fmac_f32 v93, v61, v89
    v_mul_f32 v94, v50, v86
    v_fmac_f32 v94, v54, v87
    v_fmac_f32 v94, v58, v88
    v_fmac_f32 v94, v62, v89
    v_mul_f32 v95, v51, v86
    v_fmac_f32 v95, v55, v87
    v_fmac_f32 v95, v59, v88
    v_fmac_f32 v95, v63, v89
    v_mul_f32 v92, v92, v90
    v_mul_f32 v93, v93, v90
    v_mul_f32 v94, v94, v90
    v_mul_f32 v95, v95, v90
    v_cvt_pk_bf16_f32 v92, v92, v93
    v_cvt_pk_bf16_f32 v93, v94, v95
    v_mul_u32_u24 v11, 272, v8
    v_lshlrev_b32 v12, 3, v9
    v_add_u32 v11, v11, v12
    ds_write_b64 v11, v[92:93] offset:0
    s_waitcnt vmcnt(0)
    v_add_f32 v72, v72, v74
    v_add_f32 v73, v73, v75
    v_add_f32 v76, v76, v78
    v_add_f32 v77, v77, v79
    v_add_f32 v72, v72, v76
    v_add_f32 v73, v73, v77
    v_lshlrev_b32 v81, 16, v80
    v_and_b32 v82, 0xffff0000, v80
    v_add_f32 v72, v72, v81
    v_add_f32 v73, v73, v82
    v_mov_b32 v81, 0x3d372713
    v_mov_b32 v82, 0xc0135761
    v_mul_f32 v74, v72, v72
    v_mul_f32 v74, v74, v81
    v_fma_f32 v74, v74, v72, v72
    v_mul_f32 v74, v74, v82
    v_exp_f32 v74, v74
    s_nop 0
    v_add_f32 v74, 1.0, v74
    v_rcp_f32 v74, v74
    s_nop 0
    v_mul_f32 v72, v72, v74
    v_mul_f32 v75, v73, v73
    v_mul_f32 v75, v75, v81
    v_fma_f32 v75, v75, v73, v73
    v_mul_f32 v75, v75, v82
    v_exp_f32 v75, v75
    s_nop 0
    v_add_f32 v75, 1.0, v75
    v_rcp_f32 v75, v75
    s_nop 0
    v_mul_f32 v73, v73, v75
    v_cvt_pk_bf16_f32 v72, v72, v73
    v_mov_b32 v73, 0
    v_mul_u32_u24 v11, 144, v8
    v_lshlrev_b32 v12, 2, v9
    v_add_u32 v11, v11, v12
    v_cmp_gt_u32 vcc, 28, v9
    v_cndmask_b32 v72, v73, v72, vcc
    ds_write_b32 v11, v72 offset:2176
    s_waitcnt lgkmcnt(0)
    s_barrier
    v_and_b32 v5, 7, v4
    v_mul_u32_u24 v6, 272, v5
    v_lshlrev_b32 v7, 4, v3
    v_add_u32 v6, v6, v7
    s_lshl_b32 s29, s28, 6
    v_add_u32 v6, s29, v6
    ds_read_b128 v[100:103], v6 offset:0
    v_mul_u32_u24 v6, 144, v5
    v_add_u32 v6, v6, v7
    v_add_u32 v6, s29, v6
    ds_read_b128 v[104:107], v6 offset:2176
    s_waitcnt lgkmcnt(0)
    v_perm_b32 v108, v18, v16, s20
    v_perm_b32 v109, v22, v20, s20
    v_perm_b32 v110, v26, v24, s20
    v_perm_b32 v111, v30, v28, s20
    s_nop 1
    v_mfma_f32_16x16x32_bf16 v[112:115], v[100:103], v[108:111], 0
    s_nop 3
    v_perm_b32 v108, v18, v16, s21
    v_perm_b32 v109, v22, v20, s21
    v_perm_b32 v110, v26, v24, s21
    v_perm_b32 v111, v30, v28, s21
    s_nop 1
    v_mfma_f32_16x16x32_bf16 v[116:119], v[100:103], v[108:111], 0
    s_nop 3
    v_perm_b32 v108, v19, v17, s20
    v_perm_b32 v109, v23, v21, s20
    v_perm_b32 v110, v27, v25, s20
    v_perm_b32 v111, v31, v29, s20
    s_nop 1
    v_mfma_f32_16x16x32_bf16 v[120:123], v[100:103], v[108:111], 0
    s_nop 3
    v_perm_b32 v108, v19, v17, s21
    v_perm_b32 v109, v23, v21, s21
    v_perm_b32 v110, v27, v25, s21
    v_perm_b32 v111, v31, v29, s21
    s_nop 1
    v_mfma_f32_16x16x32_bf16 v[124:127], v[100:103], v[108:111], 0
    s_nop 3
    s_nop 7
    v_lshlrev_b32 v7, 10, v3
    v_lshlrev_b32 v6, 4, v4
    v_add_u32 v7, v7, v6
    s_lshl_b32 s29, s28, 11
    v_add_u32 v7, s29, v7
    v_cmp_gt_u32 vcc, 32, v1
    s_and_saveexec_b64 s[36:37], vcc
    ds_write_b32 v7, v112 offset:3328
    ds_write_b32 v7, v116 offset:3332
    ds_write_b32 v7, v120 offset:3336
    ds_write_b32 v7, v124 offset:3340
    ds_write_b32 v7, v113 offset:3584
    ds_write_b32 v7, v117 offset:3588
    ds_write_b32 v7, v121 offset:3592
    ds_write_b32 v7, v125 offset:3596
    ds_write_b32 v7, v114 offset:3840
    ds_write_b32 v7, v118 offset:3844
    ds_write_b32 v7, v122 offset:3848
    ds_write_b32 v7, v126 offset:3852
    ds_write_b32 v7, v115 offset:4096
    ds_write_b32 v7, v119 offset:4100
    ds_write_b32 v7, v123 offset:4104
    ds_write_b32 v7, v127 offset:4108
    s_mov_b64 exec, s[36:37]
    s_cmp_ge_u32 s28, 2
    s_cbranch_scc1 K2_NOW2
    v_perm_b32 v108, v34, v32, s20
    v_perm_b32 v109, v38, v36, s20
    v_perm_b32 v110, v42, v40, s20
    v_perm_b32 v111, v46, v44, s20
    s_nop 1
    v_mfma_f32_16x16x32_bf16 v[112:115], v[104:107], v[108:111], 0
    s_nop 3
    v_perm_b32 v108, v34, v32, s21
    v_perm_b32 v109, v38, v36, s21
    v_perm_b32 v110, v42, v40, s21
    v_perm_b32 v111, v46, v44, s21
    s_nop 1
    v_mfma_f32_16x16x32_bf16 v[116:119], v[104:107], v[108:111], 0
    s_nop 3
    v_perm_b32 v108, v35, v33, s20
    v_perm_b32 v109, v39, v37, s20
    v_perm_b32 v110, v43, v41, s20
    v_perm_b32 v111, v47, v45, s20
    s_nop 1
    v_mfma_f32_16x16x32_bf16 v[120:123], v[104:107], v[108:111], 0
    s_nop 3
    v_perm_b32 v108, v35, v33, s21
    v_perm_b32 v109, v39, v37, s21
    v_perm_b32 v110, v43, v41, s21
    v_perm_b32 v111, v47, v45, s21
    s_nop 1
    v_mfma_f32_16x16x32_bf16 v[124:127], v[104:107], v[108:111], 0
    s_nop 3
    s_nop 7
    s_and_saveexec_b64 s[36:37], vcc
    ds_write_b32 v7, v112 offset:11520
    ds_write_b32 v7, v116 offset:11524
    ds_write_b32 v7, v120 offset:11528
    ds_write_b32 v7, v124 offset:11532
    ds_write_b32 v7, v113 offset:11776
    ds_write_b32 v7, v117 offset:11780
    ds_write_b32 v7, v121 offset:11784
    ds_write_b32 v7, v125 offset:11788
    ds_write_b32 v7, v114 offset:12032
    ds_write_b32 v7, v118 offset:12036
    ds_write_b32 v7, v122 offset:12040
    ds_write_b32 v7, v126 offset:12044
    ds_write_b32 v7, v115 offset:12288
    ds_write_b32 v7, v119 offset:12292
    ds_write_b32 v7, v123 offset:12296
    ds_write_b32 v7, v127 offset:12300
    s_mov_b64 exec, s[36:37]
K2_NOW2:
    s_waitcnt lgkmcnt(0)
    s_barrier
    v_lshlrev_b32 v5, 3, v0
    ds_read_b64 v[8:9], v5 offset:3328
    ds_read_b64 v[10:11], v5 offset:5376
    ds_read_b64 v[12:13], v5 offset:7424
    ds_read_b64 v[14:15], v5 offset:9472
    ds_read_b64 v[16:17], v5 offset:11520
    ds_read_b64 v[18:19], v5 offset:13568
    s_waitcnt lgkmcnt(0)
    v_add_f32 v8, v8, v10
    v_add_f32 v9, v9, v11
    v_add_f32 v8, v8, v12
    v_add_f32 v9, v9, v13
    v_add_f32 v8, v8, v14
    v_add_f32 v9, v9, v15
    v_add_f32 v8, v8, v16
    v_add_f32 v9, v9, v17
    v_add_f32 v8, v8, v18
    v_add_f32 v9, v9, v19
    v_lshrrev_b32 v6, 5, v0
    v_lshlrev_b32 v6, 11, v6
    v_and_b32 v7, 31, v0
    v_lshlrev_b32 v7, 3, v7
    v_add_u32 v6, v6, v7
    s_lshl_b32 s29, s23, 8
    v_add_u32 v6, s29, v6
    v_add_u32 v10, 0x190000, v6
    global_atomic_add_f32 v10, v8, s[18:19] sc1
    global_atomic_add_f32 v10, v9, s[18:19] offset:4 sc1
    s_waitcnt vmcnt(0)
    s_barrier
    s_cmp_lg_u32 s28, 0
    s_cbranch_scc1 K2_W1
    s_lshl_b32 s29, s23, 5
    v_mov_b32 v11, s29
    v_mov_b32 v12, 1
    v_cmp_eq_u32 vcc, 0, v1
    s_and_saveexec_b64 s[36:37], vcc
    global_atomic_add v12, v11, v12, s[16:17] sc0 sc1
    s_waitcnt vmcnt(0)
    v_mov_b32 v13, 0
    ds_write_b32 v13, v12 offset:0
    s_waitcnt lgkmcnt(0)
    s_mov_b64 exec, s[36:37]
K2_W1:
    s_barrier
    v_mov_b32 v13, 0
    ds_read_b32 v12, v13 offset:0
    s_waitcnt lgkmcnt(0)
    v_readfirstlane_b32 s29, v12
    s_cmp_eq_u32 s29, 31
    s_cbranch_scc0 K2_END
    global_load_dwordx2 v[8:9], v10, s[18:19] sc1
    v_lshrrev_b32 v7, 1, v6
    global_load_dword v14, v7, s[4:5]
    s_lshl_b32 s29, s23, 7
    v_and_b32 v15, 31, v0
    v_lshlrev_b32 v15, 2, v15
    v_add_u32 v15, s29, v15
    global_load_dword v16, v15, s[12:13]
    s_waitcnt vmcnt(0)
    v_lshlrev_b32 v17, 16, v14
    v_and_b32 v18, 0xffff0000, v14
    v_add_f32 v8, v8, v17
    v_add_f32 v9, v9, v18
    v_lshlrev_b32 v17, 16, v16
    v_and_b32 v18, 0xffff0000, v16
    v_add_f32 v8, v8, v17
    v_add_f32 v9, v9, v18
    v_cvt_pk_bf16_f32 v8, v8, v9
    global_store_dword v7, v8, s[14:15]
K2_END:
    s_endpgm
.section .rodata,"a"
.p2align 6
.amdhsa_kernel k0_proj_kernel
  .amdhsa_next_free_vgpr 256
  .amdhsa_next_free_sgpr 102
  .amdhsa_accum_offset 256
  .amdhsa_group_segment_fixed_size 0
  .amdhsa_kernarg_size 104
  .amdhsa_user_sgpr_count 2
  .amdhsa_user_sgpr_kernarg_segment_ptr 1
  .amdhsa_system_sgpr_workgroup_id_x 1
.end_amdhsa_kernel
.p2align 6
.amdhsa_kernel k1_attn_kernel
  .amdhsa_next_free_vgpr 256
  .amdhsa_next_free_sgpr 102
  .amdhsa_accum_offset 256
  .amdhsa_group_segment_fixed_size 0
  .amdhsa_kernarg_size 104
  .amdhsa_user_sgpr_count 2
  .amdhsa_user_sgpr_kernarg_segment_ptr 1
  .amdhsa_system_sgpr_workgroup_id_x 1
.end_amdhsa_kernel
.p2align 6
.amdhsa_kernel parallel_sum__sliding_block_cached__dense_activation_gelu__decode_kernel
  .amdhsa_next_free_vgpr 128
  .amdhsa_next_free_sgpr 102
  .amdhsa_accum_offset 128
  .amdhsa_group_segment_fixed_size 0
  .amdhsa_kernarg_size 104
  .amdhsa_user_sgpr_count 2
  .amdhsa_user_sgpr_kernarg_segment_ptr 1
  .amdhsa_system_sgpr_workgroup_id_x 1
.end_amdhsa_kernel
```
